```python
import torch

def _softmax(x, axis=-1):
    return torch.softmax(x, dim=axis)
def _gelu(x):
    return torch.nn.functional.gelu(x, approximate="tanh")
def _silu(x):
    return torch.nn.functional.silu(x)
def _sigmoid(x):
    return torch.sigmoid(x)
def _layernorm(x, axis=-1, eps=1e-5):
    m = x.mean(dim=axis, keepdim=True)
    v = x.var(dim=axis, keepdim=True, unbiased=False)
    return (x - m) / torch.sqrt(v + eps)
def _scatter_add(tgt, idx, src, axis=0):
    return tgt.clone().index_add_(axis, idx, src)
def _segment_sum(src, seg, n):
    out = torch.zeros((n,) + src.shape[1:], dtype=src.dtype)
    return out.index_add_(0, seg, src)
def _pad(x, pw):
    flat = tuple(v for pair in reversed(pw) for v in pair)
    return torch.nn.functional.pad(x, flat)

kernel_name = 'standalone__weight_only_int_quip__prompt'

def setup_inputs():

    _w = (lambda a: (lambda t: t.to(torch.bfloat16) if t.is_floating_point() else t)(torch.as_tensor(a)))
    B, S, D, F = 1, 2048, 640, 1728
    G = 64 if 64 > 0 else D
    D = (D // G) * G
    ng = D // G
    bits = 8 if 8 > 0 else 4
    qmax = 1 << bits
    qw = torch.randint(0, qmax, (D, F)).to(torch.int32)
    U, _ = (lambda *_a, **_k: torch.linalg.qr(*[torch.as_tensor(_x).float() for _x in _a], **_k))((lambda *s: torch.randn(*s, dtype=torch.bfloat16) * 0.05)(D, D))
    V, _ = (lambda *_a, **_k: torch.linalg.qr(*[torch.as_tensor(_x).float() for _x in _a], **_k))((lambda *s: torch.randn(*s, dtype=torch.bfloat16) * 0.05)(F, F))
    return {
        "x": _w((lambda *s: torch.randn(*s, dtype=torch.bfloat16) * 0.05)(B, S, D)),
        "qw": _w(qw),
        "scales": _w(torch.abs((lambda *s: torch.randn(*s, dtype=torch.bfloat16) * 0.05)(ng, F)) * 0.02 + 0.005),
        "zeros": _w(torch.full((ng, F), qmax / 2.0, dtype=float)),
        "U": _w(U.to(float)),
        "V": _w(V.to(float)),
    }

def reference(x, qw, scales, zeros, U, V):
    B, S, D = x.shape
    ng, F = scales.shape
    G = D // ng
    s = (lambda x, n, axis: torch.repeat_interleave(x, n, dim=axis))(scales, G, axis=0)
    z = (lambda x, n, axis: torch.repeat_interleave(x, n, dim=axis))(zeros, G, axis=0)
    wq = ((lambda x, dt: x.to(dt))(qw, x.dtype) - z) * s
    xr = torch.einsum("bsd,de->bse", x, U)
    h  = torch.einsum("bse,ef->bsf", xr, wq)
    y  = torch.einsum("bsf,fg->bsg", h, V)
    return y
```

```asm
; @launch grid=(256,1,1) block=(256,1,1) lds=163840
.amdgcn_target "amdgcn-amd-amdhsa--gfx950"
.text
.globl standalone__weight_only_int_quip__prompt_kernel
.p2align 12
.p2align 8
.type standalone__weight_only_int_quip__prompt_kernel,@function
standalone__weight_only_int_quip__prompt_kernel:
  s_cmp_ge_u32 s2, 256
  s_cbranch_scc1 L_end
  s_load_dwordx16 s[16:31], s[0:1], 0
  s_load_dwordx2 s[32:33], s[0:1], 64
  v_lshrrev_b32 v1, 6, v0
  s_mov_b32 s0, 0
  v_readfirstlane_b32 s3, v1
  s_lshr_b32 s6, s2, 3
  v_and_b32 v0, 63, v0
  s_lshl_b32 s9, s6, 1
  s_add_u32 s9, s9, s3
  s_cmp_lt_u32 s3, 2
  s_cbranch_scc1 L_sc0done
  s_cmp_ge_u32 s9, 10
  s_cbranch_scc1 L_sc0done
  s_mov_b32 s0, 2
  s_mov_b64 exec, 0
  s_cmp_eq_u32 s9, 2
  s_cbranch_scc1 L_stub0
  s_cmp_eq_u32 s9, 3
  s_cbranch_scc1 L_stub1
  s_cmp_eq_u32 s9, 4
  s_cbranch_scc1 L_stub2
  s_cmp_eq_u32 s9, 5
  s_cbranch_scc1 L_stub3
  s_cmp_eq_u32 s9, 6
  s_cbranch_scc1 L_stub4
  s_cmp_eq_u32 s9, 7
  s_cbranch_scc1 L_stub13
  s_cmp_eq_u32 s9, 8
  s_cbranch_scc1 L_stub14
  s_branch L_stub15
L_scret:
  s_cmp_eq_u32 s0, 1
  s_cbranch_scc1 L_scback
  s_cmp_eq_u32 s0, 2
  s_cbranch_scc0 L_end
  s_mov_b32 s0, 0
  s_mov_b64 exec, -1
L_sc0done:
  v_lshrrev_b32 v1, 4, v0
  v_and_b32 v2, 15, v0
  s_and_b32 s5, s2, 7
  s_cmp_ge_u32 s6, 27
  s_cbranch_scc1 L_roleB
  s_mul_i32 s9, s5, 27
  s_add_u32 s9, s9, s6
  s_and_b32 s7, s9, 7
  s_lshr_b32 s8, s9, 3
  v_lshrrev_b32 v16, 3, v0
  v_mul_u32_u24 v16, 6912, v16
  v_and_b32 v17, 7, v0
  v_xor_b32 v17, v17, v1
  v_lshl_add_u32 v3, v17, 4, v16
  v_xor_b32 v17, 4, v17
  v_lshl_add_u32 v7, v17, 4, v16
  v_add_u32 v7, 54272, v7
  v_mul_u32_u24 v20, 1280, v0
  s_mul_i32 s35, s7, 5
  s_add_u32 s35, s35, s3
  s_lshl_b32 s77, s8, 8
  s_cmp_ge_u32 s3, 1
  s_cselect_b32 s72, -1, 4
  s_cselect_b32 s74, 128, 0
  s_add_u32 s72, s72, s35
  s_add_u32 s73, s35, 3
  s_add_u32 s74, s74, s77
  s_add_u32 s76, s77, 128
  s_mul_i32 s11, s35, 110592
  s_add_u32 s11, s11, s77
  s_mul_i32 s12, s72, 110592
  s_add_u32 s12, s12, s74
  s_mul_i32 s13, s73, 110592
  s_add_u32 s13, s13, s76
  s_mul_i32 s75, s3, 40960
  s_waitcnt lgkmcnt(0)
  s_mov_b32 s36, s18
  s_and_b32 s37, s19, 0xffff
  s_mov_b32 s38, 0x438000
  s_mov_b32 s39, 0x20000
  s_mov_b32 s60, s16
  s_and_b32 s61, s17, 0xffff
  s_mov_b32 s62, 0x280000
  s_mov_b32 s63, 0x20000
  s_mov_b32 s68, s24
  s_and_b32 s69, s25, 0xffff
  s_mov_b32 s70, 0xc8000
  s_mov_b32 s71, 0x20000
  s_cmp_lg_u32 s3, 2
  s_cbranch_scc1 L_pfd0
  s_add_u32 s14, s6, 0
  s_cmp_ge_u32 s14, 140
  s_cbranch_scc1 L_pfd0
  s_mul_i32 s15, s14, 4682
  s_lshr_b32 s15, s15, 16
  s_mul_i32 s34, s15, 14
  s_sub_u32 s34, s14, s34
  s_cmp_ge_u32 s34, 4
  s_cbranch_scc1 L_pfu0
  s_lshl_b32 s14, s5, 2
  s_add_u32 s14, s14, s34
  s_mul_i32 s14, s14, 81920
  s_lshl_b32 s15, s15, 7
  s_add_u32 s14, s14, s15
  buffer_load_dword v23, v20, s[60:63], s14 offen
  s_branch L_pfd0
L_pfu0:
  s_mul_i32 s14, s15, 81920
  s_lshl_b32 s34, s34, 7
L_stub0:
  s_cbranch_execz L_scret
  s_add_u32 s14, s14, s34
  s_sub_u32 s14, s14, 512
  buffer_load_dword v23, v20, s[68:71], s14 offen
L_pfd0:
  s_add_u32 m0, s75, 32768
  s_lshr_b32 s9, s35, 2
  buffer_load_dwordx4 v3, s[36:39], s11 offen  lds
  buffer_load_dwordx4 v7, s[36:39], s11 offen offset:1024  lds
  s_mul_i32 s14, s9, 3456
  s_lshr_b32 s9, s77, 1
  s_add_u32 s14, s14, s9
  s_add_u32 m0, s75, 34816
  s_lshr_b32 s9, s72, 2
  buffer_load_dwordx4 v3, s[36:39], s12 offen  lds
  buffer_load_dwordx4 v7, s[36:39], s12 offen offset:1024  lds
  s_mul_i32 s15, s9, 3456
  s_lshr_b32 s9, s74, 1
  s_add_u32 s15, s15, s9
  v_lshlrev_b32 v4, 4, v1
  s_mov_b32 s40, s20
  s_and_b32 s41, s21, 0xffff
  s_mov_b32 s42, 0x8700
  s_mov_b32 s43, 0x20000
  s_mov_b32 s44, s22
  s_and_b32 s45, s23, 0xffff
  s_mov_b32 s46, 0x8700
  s_mov_b32 s47, 0x20000
  s_cmp_ge_u32 s3, 2
  s_cbranch_scc1 L_no3a
  s_add_u32 m0, s75, 36864
  s_lshr_b32 s9, s73, 2
  buffer_load_dwordx4 v3, s[36:39], s13 offen  lds
  buffer_load_dwordx4 v7, s[36:39], s13 offen offset:1024  lds
  s_mul_i32 s34, s9, 3456
  s_lshr_b32 s9, s76, 1
  s_add_u32 s34, s34, s9
  buffer_load_dwordx4 v[64:67], v4, s[40:43], s34 offen
  buffer_load_dwordx4 v[76:79], v4, s[44:47], s34 offen
L_no3a:
  buffer_load_dwordx4 v[56:59], v4, s[40:43], s14 offen
  buffer_load_dwordx4 v[68:71], v4, s[44:47], s14 offen
  buffer_load_dwordx4 v[60:63], v4, s[40:43], s15 offen
  buffer_load_dwordx4 v[72:75], v4, s[44:47], s15 offen
  s_mov_b32 s48, s26
  s_and_b32 s49, s27, 0xffff
  s_mov_b32 s50, 0x5b2000
  s_mov_b32 s51, 0x20000
  v_mul_u32_u24 v21, 3456, v0
  s_mul_i32 s9, s5, 27
  s_lshr_b32 s56, s9, 3
  s_add_u32 s9, s9, 34
  s_lshr_b32 s9, s9, 3
  s_sub_u32 s57, s9, s56
  s_movk_i32 s58, 16384
  s_cmp_eq_u32 s57, 5
  s_cselect_b32 s58, 13108, s58
  s_barrier
  s_movk_i32 s11, 255
  s_cmp_eq_u32 s3, 3
  s_cselect_b32 s11, 27, s11
  s_cmp_eq_u32 s3, 1
  s_cselect_b32 s11, 54, s11
  s_add_u32 s11, s11, s6
  s_cmp_ge_u32 s11, 140
  s_cbranch_scc1 L_pfd1
  s_mul_i32 s12, s11, 4682
  s_lshr_b32 s12, s12, 16
  s_mul_i32 s13, s12, 14
  s_sub_u32 s13, s11, s13
  s_cmp_ge_u32 s13, 4
  s_cbranch_scc1 L_pfu1
  s_lshl_b32 s11, s5, 2
  s_add_u32 s11, s11, s13
  s_mul_i32 s11, s11, 81920
  s_lshl_b32 s12, s12, 7
  s_add_u32 s11, s11, s12
  buffer_load_dword v23, v20, s[60:63], s11 offen
  s_branch L_pfd1
L_pfu1:
  s_mul_i32 s11, s12, 81920
  s_lshl_b32 s13, s13, 7
  s_add_u32 s11, s11, s13
  s_sub_u32 s11, s11, 512
  buffer_load_dword v23, v20, s[68:71], s11 offen
L_pfd1:
  s_movk_i32 s11, 255
  s_cmp_eq_u32 s3, 0
  s_cselect_b32 s11, 0, s11
  s_cmp_eq_u32 s3, 1
  s_cselect_b32 s11, 27, s11
  s_cmp_eq_u32 s3, 2
  s_cselect_b32 s11, 54, s11
  s_cmp_eq_u32 s3, 3
  s_cselect_b32 s11, 81, s11
  s_add_u32 s11, s11, s6
  s_mul_i32 s12, s11, s58
  s_lshr_b32 s12, s12, 16
  s_cmp_ge_u32 s12, 27
  s_cbranch_scc1 L_pfd2
  s_mul_i32 s13, s12, s57
  s_sub_u32 s13, s11, s13
  s_add_u32 s13, s13, s56
  s_mul_i32 s11, s12, 221184
  s_lshl_b32 s13, s13, 7
  s_add_u32 s11, s11, s13
  buffer_load_dword v23, v21, s[48:51], s11 offen
L_pfd2:
  s_cmp_lg_u32 s3, 0
  s_cbranch_scc1 L_pfd3
  s_add_u32 s11, s6, 108
  s_mul_i32 s12, s11, s58
  s_lshr_b32 s12, s12, 16
  s_cmp_ge_u32 s12, 27
  s_cbranch_scc1 L_pfd3
  s_mul_i32 s13, s12, s57
  s_sub_u32 s13, s11, s13
  s_add_u32 s13, s13, s56
  s_mul_i32 s11, s12, 221184
  s_lshl_b32 s13, s13, 7
  s_add_u32 s11, s11, s13
  buffer_load_dword v23, v21, s[48:51], s11 offen
L_pfd3:
  s_add_u32 s10, s32, 0x770000
  s_addc_u32 s11, s33, 0
  s_load_dword s4, s[10:11], 0
  s_cmp_lg_u32 s3, 3
  s_cbranch_scc1 L_scdone
  s_mov_b32 s0, 1
  s_mov_b64 exec, 0
  s_cmp_eq_u32 s6, 3
  s_cbranch_scc1 L_stub5
  s_cmp_eq_u32 s6, 4
  s_cbranch_scc1 L_stub6
  s_cmp_eq_u32 s6, 5
  s_cbranch_scc1 L_stub7
  s_cmp_eq_u32 s6, 6
  s_cbranch_scc1 L_stub8
  s_cmp_eq_u32 s6, 7
  s_cbranch_scc1 L_stub9
  s_cmp_eq_u32 s6, 8
  s_cbranch_scc1 L_stub10
  s_cmp_eq_u32 s6, 9
  s_cbranch_scc1 L_stub11
  s_cmp_eq_u32 s6, 10
  s_cbranch_scc1 L_stub12
  s_cmp_eq_u32 s6, 11
  s_cbranch_scc1 L_stub16
  s_cmp_eq_u32 s6, 12
  s_cbranch_scc1 L_stub17
  s_cmp_eq_u32 s6, 13
  s_cbranch_scc1 L_stub18
  s_cmp_eq_u32 s6, 14
  s_cbranch_scc1 L_stub19
  s_cmp_eq_u32 s6, 15
  s_cbranch_scc1 L_stub20
  s_cmp_eq_u32 s6, 16
  s_cbranch_scc1 L_stub21
  s_cmp_eq_u32 s6, 17
  s_cbranch_scc1 L_stub22
  s_cmp_eq_u32 s6, 18
  s_cbranch_scc1 L_stub23
L_scback:
  s_mov_b32 s0, 0
  s_mov_b64 exec, -1
L_scdone:
  v_lshrrev_b32 v16, 3, v0
  v_mul_u32_u24 v16, 3456, v16
  v_and_b32 v17, 7, v0
  v_and_b32 v18, 1, v1
  v_lshlrev_b32 v18, 1, v18
  v_xor_b32 v17, v17, v18
  v_xor_b32 v18, 4, v17
  v_lshl_add_u32 v8, v17, 4, v16
  v_lshl_add_u32 v9, v18, 4, v16
  v_add_u32 v9, 26624, v9
  v_lshl_add_u32 v10, v17, 4, v16
L_stub1:
  s_cbranch_execz L_scret
  v_add_u32 v10, 53248, v10
  v_lshl_add_u32 v11, v18, 4, v16
  v_add_u32 v11, 79872, v11
  s_cmp_ge_u32 s3, 2
  s_cselect_b32 s9, 4, 0
  s_sub_u32 s76, s3, s9
  s_mul_i32 s74, s76, 110592
  s_lshl_b32 s10, s8, 7
  s_add_u32 s74, s74, s10
  s_mov_b32 s52, s32
  s_and_b32 s53, s33, 0xffff
  s_mov_b32 s54, 0x21c000
  s_mov_b32 s55, 0x20000
  s_add_u32 s64, s32, 0x700000
  s_addc_u32 s65, s33, 0
  s_and_b32 s65, s65, 0xffff
  s_mov_b32 s66, 0x80000
  s_mov_b32 s67, 0x20000
  v_lshlrev_b32 v5, 4, v0
  v_add_u32 v6, 4096, v5
  s_mul_i32 s77, s7, 27
  s_add_u32 s77, s77, s8
  s_mul_i32 s77, s77, 10240
  s_lshl_b32 s9, s3, 10
  s_add_u32 s35, s77, s9
  s_add_u32 s72, s35, 4096
  s_add_u32 s73, s35, 8192
  v_lshrrev_b32 v16, 1, v2
  v_lshlrev_b32 v17, 1, v1
  v_xor_b32 v16, v16, v17
  v_lshlrev_b32 v17, 7, v2
  v_add_u32 v17, s75, v17
  v_lshl_add_u32 v22, v16, 4, v17
  v_xor_b32 v16, 1, v16
  v_lshl_add_u32 v24, v16, 4, v17
  v_bfe_u32 v16, v0, 2, 2
  v_and_b32 v17, 3, v0
  v_lshlrev_b32 v19, 10, v1
  v_lshl_add_u32 v19, v16, 7, v19
  v_lshl_add_u32 v19, v17, 3, v19
  v_add_u32 v19, s75, v19
  v_lshrrev_b32 v16, 1, v16
  v_and_b32 v17, 1, v1
  v_lshl_or_b32 v16, v17, 1, v16
  v_xor_b32 v16, s3, v16
  v_xor_b32 v17, 0, v16
  v_lshl_add_u32 v12, v17, 5, v19
  v_xor_b32 v17, 1, v16
  v_lshl_add_u32 v13, v17, 5, v19
  v_xor_b32 v17, 2, v16
  v_lshl_add_u32 v14, v17, 5, v19
  v_xor_b32 v17, 3, v16
  v_lshl_add_u32 v15, v17, 5, v19
  s_lshr_b32 s9, s5, 1
  s_and_b32 s10, s5, 1
  s_mul_i32 s11, s9, 4
  s_lshr_b32 s9, s6, 3
  s_add_u32 s11, s11, s9
  s_mul_i32 s12, s10, 8
  s_and_b32 s9, s6, 7
  s_add_u32 s12, s12, s9
  v_lshlrev_b32 v96, 4, v0
  v_add_u32 v97, 4096, v96
  v_add_u32 v104, 0x10000, v96
  v_add_u32 v105, 0x20000, v96
  s_add_u32 s9, s11, s12
  s_add_u32 s10, s9, 0
  s_and_b32 s10, s10, 3
  s_mul_i32 s16, s10, 5120
  s_add_u32 s10, s9, 1
  s_and_b32 s10, s10, 3
  s_mul_i32 s17, s10, 5120
  s_add_u32 s10, s9, 2
  s_and_b32 s10, s10, 3
  s_mul_i32 s18, s10, 5120
  s_add_u32 s10, s9, 3
  s_and_b32 s10, s10, 3
  s_mul_i32 s19, s10, 5120
  v_min_u32 v106, 39, v0
  v_mul_u32_u24 v107, 13, v106
  v_lshrrev_b32 v107, 6, v107
  v_mul_u32_u24 v98, 5, v107
  v_sub_u32 v98, v106, v98
  s_lshr_b32 s9, s11, 1
  v_mov_b32 v106, s9
  s_cmp_eq_u32 s2, 0
  s_cselect_b64 vcc, -1, 0
  v_cndmask_b32 v107, v106, v107, vcc
  v_add_u32 v107, 40, v107
  v_lshlrev_b32 v107, 8, v107
  v_lshl_add_u32 v98, v98, 2, v107
  s_mul_i32 s9, s12, 112
  s_add_u32 s10, s9, 111
  s_lshr_b32 s9, s9, 6
  s_lshr_b32 s10, s10, 6
  s_min_u32 s10, s10, 26
  v_lshrrev_b32 v106, 3, v0
  v_add_u32 v106, s9, v106
  v_min_u32 v106, s10, v106
  v_add_u32 v106, 8, v106
  v_lshlrev_b32 v106, 8, v106
  v_and_b32 v107, 7, v0
  v_lshl_add_u32 v99, v107, 2, v106
  s_lshl_b32 s9, s11, 2
  s_add_u32 s9, s9, s3
  s_mul_i32 s20, s9, 40960
  s_mul_i32 s9, s9, 110592
  s_mul_i32 s10, s12, 224
  s_add_u32 s21, s9, s10
  s_add_u32 s22, s21, 55296
  v_mul_u32_u24 v106, 3456, v2
  v_lshl_add_u32 v100, v1, 4, v106
  v_lshl_add_u32 v101, v1, 3, v106
  v_mov_b32 v107, 0x7f000000
  s_cmp_eq_u32 s12, 15
  s_cselect_b64 vcc, -1, 0
  v_cndmask_b32 v103, v100, v107, vcc
  v_cndmask_b32 v101, v101, v107, vcc
  s_mov_b32 vcc_lo, 0
  v_cndmask_b32 v102, v100, v107, vcc
  s_mul_i32 s12, s12, 143360
  s_lshr_b32 s9, s3, 1
  s_mul_i32 s9, s9, 20480
  s_and_b32 s10, s3, 1
  s_mul_i32 s23, s10, 5120
  s_add_u32 s23, s23, s9
  s_cmp_eq_u32 s10, 0
  s_cselect_b32 s24, s16, s17
  s_cselect_b32 s25, s18, s19
  s_cmp_lt_u32 s3, 2
  s_cselect_b32 s27, s24, s25
  s_add_u32 s27, s27, s12
  s_add_u32 s12, s12, s9
  s_add_u32 s24, s24, s12
  s_add_u32 s25, s25, s12
  s_mul_i32 s26, s3, 5120
  s_add_u32 s44, s32, 0x240000
  s_addc_u32 s45, s33, 0
  s_and_b32 s45, s45, 0xffff
  s_mov_b32 s46, 0x221000
  s_mov_b32 s47, 0x20000
  s_add_u32 s40, s32, 0x480000
  s_addc_u32 s41, s33, 0
  s_and_b32 s41, s41, 0xffff
  s_mov_b32 s42, 0x280000
  s_mov_b32 s43, 0x20000
  s_lshl_b32 s77, s7, 8
  s_lshl_b32 s9, s8, 2
  s_add_u32 s77, s77, s9
  v_min_u32 v25, 26, v0
  v_lshlrev_b32 v25, 2, v25
  s_lshl_b32 s10, s7, 8
  v_add_u32 v25, s10, v25
  s_lshl_b32 s13, s8, 2
  s_add_u32 s13, s13, s3
  s_mul_i32 s14, s13, 9363
  s_lshr_b32 s14, s14, 16
  s_mul_i32 s10, s14, 7
  s_sub_u32 s15, s13, s10
  s_and_b32 s9, s15, 6
  s_add_u32 s10, s10, s9
  s_mul_i32 s10, s10, 20480
  s_and_b32 s9, s15, 1
  s_lshl_b32 s9, s9, 7
  s_add_u32 s10, s10, s9
  s_mul_i32 s9, s7, 2560
L_stub2:
  s_cbranch_execz L_scret
  s_add_u32 s34, s10, s9
  v_bfe_u32 v16, v2, 2, 1
  v_mul_u32_u24 v16, 20480, v16
  v_lshrrev_b32 v17, 3, v2
  v_lshl_add_u32 v16, v17, 6, v16
  v_and_b32 v17, 3, v2
  v_lshl_add_u32 v16, v17, 4, v16
  v_lshlrev_b32 v17, 4, v2
  s_cmp_eq_u32 s15, 6
  s_cselect_b64 vcc, -1, 0
  v_cndmask_b32 v16, v16, v17, vcc
  v_and_b32 v17, 1, v1
  v_lshrrev_b32 v18, 1, v1
  v_lshl_add_u32 v16, v18, 8, v16
  v_lshl_add_u32 v4, v17, 3, v16
  v_lshl_add_u32 v3, v17, 9, v16
  s_add_u32 s78, s8, 8
  s_lshl_b32 s78, s78, 8
  s_lshl_b32 s9, s7, 2
  s_add_u32 s78, s78, s9
  s_xor_b32 s10, s3, 0
  s_mul_i32 s10, s10, 40960
  s_add_u32 s10, s10, 20480
  v_add_u32 v120, s10, v5
  s_xor_b32 s10, s3, 1
  s_mul_i32 s10, s10, 40960
  s_add_u32 s10, s10, 20480
  v_add_u32 v121, s10, v5
  s_xor_b32 s10, s3, 2
  s_mul_i32 s10, s10, 40960
  s_add_u32 s10, s10, 20480
  v_add_u32 v122, s10, v5
  s_xor_b32 s10, s3, 3
  s_mul_i32 s10, s10, 40960
  s_add_u32 s10, s10, 20480
  v_add_u32 v123, s10, v5
  s_mul_i32 s11, s7, 54
  s_add_u32 s11, s11, s76
  s_mul_i32 s11, s11, 5120
  s_cmp_lg_u32 s3, 0
  s_cbranch_scc1 L_w1_n
  s_cmp_lg_u32 s57, 5
  s_cbranch_scc1 L_w1_n
  s_waitcnt vmcnt(2)
  s_branch L_w1_d
L_w1_n:
  s_mov_b32 s9, 10
  s_bitcmp1_b32 s9, s3
  s_cbranch_scc1 L_w1_1
  s_waitcnt vmcnt(1)
L_w1_1:
  s_waitcnt vmcnt(2)
L_w1_d:
  ds_read_b128 v[32:35], v22 offset:32768
  ds_read_b128 v[36:39], v24 offset:32768
  ds_read_b128 v[40:43], v22 offset:34816
  ds_read_b128 v[44:47], v24 offset:34816
  ds_read_b128 v[48:51], v22 offset:36864
  ds_read_b128 v[52:55], v24 offset:36864
  v_lshlrev_b32 v152, 16, v68
  v_and_b32 v153, 0xffff0000, v68
  v_lshlrev_b32 v154, 16, v69
  v_and_b32 v155, 0xffff0000, v69
  v_lshlrev_b32 v156, 16, v70
  v_and_b32 v157, 0xffff0000, v70
  v_lshlrev_b32 v158, 16, v71
  v_and_b32 v159, 0xffff0000, v71
  s_waitcnt lgkmcnt(0)
  v_cvt_f32_i32 v32, v32
  v_cvt_f32_i32 v33, v33
  v_cvt_f32_i32 v34, v34
  v_cvt_f32_i32 v35, v35
  v_cvt_f32_i32 v36, v36
  v_cvt_f32_i32 v37, v37
  v_cvt_f32_i32 v38, v38
  v_cvt_f32_i32 v39, v39
  v_cvt_pk_bf16_f32 v176, v32, v33
  v_cvt_pk_bf16_f32 v177, v34, v35
  v_cvt_pk_bf16_f32 v178, v36, v37
  v_cvt_pk_bf16_f32 v179, v38, v39
  v_lshlrev_b32 v32, 16, v176
  v_and_b32 v33, 0xffff0000, v176
  v_lshlrev_b32 v34, 16, v177
  v_and_b32 v35, 0xffff0000, v177
  v_lshlrev_b32 v36, 16, v178
  v_and_b32 v37, 0xffff0000, v178
  v_lshlrev_b32 v38, 16, v179
  v_and_b32 v39, 0xffff0000, v179
  v_pk_add_f32 v[32:33], v[32:33], v[152:153] neg_lo:[0,1] neg_hi:[0,1]
  v_pk_add_f32 v[34:35], v[34:35], v[154:155] neg_lo:[0,1] neg_hi:[0,1]
  v_pk_add_f32 v[36:37], v[36:37], v[156:157] neg_lo:[0,1] neg_hi:[0,1]
  v_pk_add_f32 v[38:39], v[38:39], v[158:159] neg_lo:[0,1] neg_hi:[0,1]
  v_cvt_pk_bf16_f32 v176, v32, v33
  v_cvt_pk_bf16_f32 v177, v34, v35
  v_cvt_pk_bf16_f32 v178, v36, v37
  v_cvt_pk_bf16_f32 v179, v38, v39
  v_lshlrev_b32 v128, 16, v56
  v_and_b32 v129, 0xffff0000, v56
  v_lshlrev_b32 v130, 16, v57
  v_and_b32 v131, 0xffff0000, v57
  v_lshlrev_b32 v132, 16, v58
  v_and_b32 v133, 0xffff0000, v58
  v_lshlrev_b32 v134, 16, v59
  v_and_b32 v135, 0xffff0000, v59
  v_lshlrev_b32 v32, 16, v176
  v_and_b32 v33, 0xffff0000, v176
  v_lshlrev_b32 v34, 16, v177
  v_and_b32 v35, 0xffff0000, v177
  v_lshlrev_b32 v36, 16, v178
  v_and_b32 v37, 0xffff0000, v178
  v_lshlrev_b32 v38, 16, v179
  v_and_b32 v39, 0xffff0000, v179
  v_pk_mul_f32 v[32:33], v[32:33], v[128:129]
  v_pk_mul_f32 v[34:35], v[34:35], v[130:131]
  v_pk_mul_f32 v[36:37], v[36:37], v[132:133]
  v_pk_mul_f32 v[38:39], v[38:39], v[134:135]
  v_cvt_pk_bf16_f32 v176, v32, v33
  v_cvt_pk_bf16_f32 v177, v34, v35
  v_cvt_pk_bf16_f32 v178, v36, v37
  v_cvt_pk_bf16_f32 v179, v38, v39
  buffer_store_dwordx4 v[176:179], v5, s[52:55], s35 offen sc1
  v_lshlrev_b32 v160, 16, v72
  v_and_b32 v161, 0xffff0000, v72
  v_lshlrev_b32 v162, 16, v73
  v_and_b32 v163, 0xffff0000, v73
  v_lshlrev_b32 v164, 16, v74
  v_and_b32 v165, 0xffff0000, v74
  v_lshlrev_b32 v166, 16, v75
  v_and_b32 v167, 0xffff0000, v75
  v_cvt_f32_i32 v40, v40
  v_cvt_f32_i32 v41, v41
  v_cvt_f32_i32 v42, v42
  v_cvt_f32_i32 v43, v43
  v_cvt_f32_i32 v44, v44
  v_cvt_f32_i32 v45, v45
  v_cvt_f32_i32 v46, v46
  v_cvt_f32_i32 v47, v47
  v_cvt_pk_bf16_f32 v180, v40, v41
  v_cvt_pk_bf16_f32 v181, v42, v43
  v_cvt_pk_bf16_f32 v182, v44, v45
  v_cvt_pk_bf16_f32 v183, v46, v47
  v_lshlrev_b32 v40, 16, v180
  v_and_b32 v41, 0xffff0000, v180
  v_lshlrev_b32 v42, 16, v181
  v_and_b32 v43, 0xffff0000, v181
  v_lshlrev_b32 v44, 16, v182
  v_and_b32 v45, 0xffff0000, v182
  v_lshlrev_b32 v46, 16, v183
  v_and_b32 v47, 0xffff0000, v183
  v_pk_add_f32 v[40:41], v[40:41], v[160:161] neg_lo:[0,1] neg_hi:[0,1]
  v_pk_add_f32 v[42:43], v[42:43], v[162:163] neg_lo:[0,1] neg_hi:[0,1]
  v_pk_add_f32 v[44:45], v[44:45], v[164:165] neg_lo:[0,1] neg_hi:[0,1]
  v_pk_add_f32 v[46:47], v[46:47], v[166:167] neg_lo:[0,1] neg_hi:[0,1]
L_stub3:
  s_cbranch_execz L_scret
  v_cvt_pk_bf16_f32 v180, v40, v41
  v_cvt_pk_bf16_f32 v181, v42, v43
  v_cvt_pk_bf16_f32 v182, v44, v45
  v_cvt_pk_bf16_f32 v183, v46, v47
  v_lshlrev_b32 v136, 16, v60
  v_and_b32 v137, 0xffff0000, v60
  v_lshlrev_b32 v138, 16, v61
  v_and_b32 v139, 0xffff0000, v61
  v_lshlrev_b32 v140, 16, v62
  v_and_b32 v141, 0xffff0000, v62
  v_lshlrev_b32 v142, 16, v63
  v_and_b32 v143, 0xffff0000, v63
  v_lshlrev_b32 v40, 16, v180
  v_and_b32 v41, 0xffff0000, v180
  v_lshlrev_b32 v42, 16, v181
  v_and_b32 v43, 0xffff0000, v181
  v_lshlrev_b32 v44, 16, v182
  v_and_b32 v45, 0xffff0000, v182
  v_lshlrev_b32 v46, 16, v183
  v_and_b32 v47, 0xffff0000, v183
  v_pk_mul_f32 v[40:41], v[40:41], v[136:137]
  v_pk_mul_f32 v[42:43], v[42:43], v[138:139]
  v_pk_mul_f32 v[44:45], v[44:45], v[140:141]
  v_pk_mul_f32 v[46:47], v[46:47], v[142:143]
  v_cvt_pk_bf16_f32 v180, v40, v41
  v_cvt_pk_bf16_f32 v181, v42, v43
  v_cvt_pk_bf16_f32 v182, v44, v45
  v_cvt_pk_bf16_f32 v183, v46, v47
  buffer_store_dwordx4 v[180:183], v5, s[52:55], s72 offen sc1
  s_cmp_ge_u32 s3, 2
  s_cbranch_scc1 L_no3b
  v_lshlrev_b32 v168, 16, v76
  v_and_b32 v169, 0xffff0000, v76
  v_lshlrev_b32 v170, 16, v77
  v_and_b32 v171, 0xffff0000, v77
  v_lshlrev_b32 v172, 16, v78
  v_and_b32 v173, 0xffff0000, v78
  v_lshlrev_b32 v174, 16, v79
  v_and_b32 v175, 0xffff0000, v79
  v_cvt_f32_i32 v48, v48
  v_cvt_f32_i32 v49, v49
  v_cvt_f32_i32 v50, v50
  v_cvt_f32_i32 v51, v51
  v_cvt_f32_i32 v52, v52
  v_cvt_f32_i32 v53, v53
  v_cvt_f32_i32 v54, v54
  v_cvt_f32_i32 v55, v55
  v_cvt_pk_bf16_f32 v184, v48, v49
  v_cvt_pk_bf16_f32 v185, v50, v51
  v_cvt_pk_bf16_f32 v186, v52, v53
  v_cvt_pk_bf16_f32 v187, v54, v55
  v_lshlrev_b32 v48, 16, v184
  v_and_b32 v49, 0xffff0000, v184
  v_lshlrev_b32 v50, 16, v185
  v_and_b32 v51, 0xffff0000, v185
  v_lshlrev_b32 v52, 16, v186
  v_and_b32 v53, 0xffff0000, v186
  v_lshlrev_b32 v54, 16, v187
  v_and_b32 v55, 0xffff0000, v187
  v_pk_add_f32 v[48:49], v[48:49], v[168:169] neg_lo:[0,1] neg_hi:[0,1]
  v_pk_add_f32 v[50:51], v[50:51], v[170:171] neg_lo:[0,1] neg_hi:[0,1]
  v_pk_add_f32 v[52:53], v[52:53], v[172:173] neg_lo:[0,1] neg_hi:[0,1]
  v_pk_add_f32 v[54:55], v[54:55], v[174:175] neg_lo:[0,1] neg_hi:[0,1]
  v_cvt_pk_bf16_f32 v184, v48, v49
  v_cvt_pk_bf16_f32 v185, v50, v51
  v_cvt_pk_bf16_f32 v186, v52, v53
  v_cvt_pk_bf16_f32 v187, v54, v55
  v_lshlrev_b32 v144, 16, v64
  v_and_b32 v145, 0xffff0000, v64
  v_lshlrev_b32 v146, 16, v65
  v_and_b32 v147, 0xffff0000, v65
  v_lshlrev_b32 v148, 16, v66
  v_and_b32 v149, 0xffff0000, v66
  v_lshlrev_b32 v150, 16, v67
  v_and_b32 v151, 0xffff0000, v67
  v_lshlrev_b32 v48, 16, v184
  v_and_b32 v49, 0xffff0000, v184
  v_lshlrev_b32 v50, 16, v185
  v_and_b32 v51, 0xffff0000, v185
  v_lshlrev_b32 v52, 16, v186
  v_and_b32 v53, 0xffff0000, v186
  v_lshlrev_b32 v54, 16, v187
  v_and_b32 v55, 0xffff0000, v187
  v_pk_mul_f32 v[48:49], v[48:49], v[144:145]
  v_pk_mul_f32 v[50:51], v[50:51], v[146:147]
  v_pk_mul_f32 v[52:53], v[52:53], v[148:149]
  v_pk_mul_f32 v[54:55], v[54:55], v[150:151]
  v_cvt_pk_bf16_f32 v184, v48, v49
  v_cvt_pk_bf16_f32 v185, v50, v51
  v_cvt_pk_bf16_f32 v186, v52, v53
  v_cvt_pk_bf16_f32 v187, v54, v55
  buffer_store_dwordx4 v[184:187], v5, s[52:55], s73 offen sc1
  s_add_u32 m0, s75, 0
  s_nop 0
  buffer_load_dwordx4 v8, s[48:51], s74 offen offset:0  lds
  buffer_load_dwordx4 v9, s[48:51], s74 offen offset:1024  lds
  buffer_load_dwordx4 v10, s[48:51], s74 offen offset:2048  lds
  buffer_load_dwordx4 v11, s[48:51], s74 offen offset:3072  lds
  s_branch L_pos0done
L_no3b:
  v_accvgpr_write_b32 a0, 0
  v_accvgpr_write_b32 a1, 0
  v_accvgpr_write_b32 a2, 0
  v_accvgpr_write_b32 a3, 0
  v_accvgpr_write_b32 a4, 0
  v_accvgpr_write_b32 a5, 0
  v_accvgpr_write_b32 a6, 0
  v_accvgpr_write_b32 a7, 0
  v_accvgpr_write_b32 a8, 0
  v_accvgpr_write_b32 a9, 0
  v_accvgpr_write_b32 a10, 0
  v_accvgpr_write_b32 a11, 0
  v_accvgpr_write_b32 a12, 0
  v_accvgpr_write_b32 a13, 0
  v_accvgpr_write_b32 a14, 0
  v_accvgpr_write_b32 a15, 0
L_pos0done:
  s_add_u32 m0, s75, 4096
  s_add_u32 s74, s74, 442368
  buffer_load_dwordx4 v8, s[48:51], s74 offen offset:0  lds
  buffer_load_dwordx4 v9, s[48:51], s74 offen offset:1024  lds
  buffer_load_dwordx4 v10, s[48:51], s74 offen offset:2048  lds
  buffer_load_dwordx4 v11, s[48:51], s74 offen offset:3072  lds
  s_add_u32 m0, s75, 8192
  s_add_u32 s74, s74, 442368
  buffer_load_dwordx4 v8, s[48:51], s74 offen offset:0  lds
  buffer_load_dwordx4 v9, s[48:51], s74 offen offset:1024  lds
  buffer_load_dwordx4 v10, s[48:51], s74 offen offset:2048  lds
  buffer_load_dwordx4 v11, s[48:51], s74 offen offset:3072  lds
  s_add_u32 m0, s75, 12288
  s_add_u32 s74, s74, 442368
  buffer_load_dwordx4 v8, s[48:51], s74 offen offset:0  lds
  buffer_load_dwordx4 v9, s[48:51], s74 offen offset:1024  lds
L_stub4:
  s_cbranch_execz L_scret
  buffer_load_dwordx4 v10, s[48:51], s74 offen offset:2048  lds
  buffer_load_dwordx4 v11, s[48:51], s74 offen offset:3072  lds
  s_add_u32 m0, s75, 16384
  s_add_u32 s74, s74, 442368
  buffer_load_dwordx4 v8, s[48:51], s74 offen offset:0  lds
  buffer_load_dwordx4 v9, s[48:51], s74 offen offset:1024  lds
  buffer_load_dwordx4 v10, s[48:51], s74 offen offset:2048  lds
  buffer_load_dwordx4 v11, s[48:51], s74 offen offset:3072  lds
  s_add_u32 s4, s4, 1
  s_or_b32 s4, s4, 0x80000000
  s_waitcnt vmcnt(16)
  s_barrier
  s_cmp_lg_u32 s3, 0
  s_cbranch_scc1 L_noflagA
  v_mov_b32 v16, s77
  v_mov_b32 v17, s4
  s_mov_b64 exec, 1
  buffer_store_dword v17, v16, s[64:67], 0 offen sc1
  s_mov_b64 exec, -1
L_noflagA:
  s_movk_i32 s9, 255
  s_cmp_eq_u32 s3, 1
  s_cselect_b32 s9, 81, s9
  s_cmp_eq_u32 s3, 2
  s_cselect_b32 s9, 108, s9
  s_cmp_eq_u32 s3, 3
  s_cselect_b32 s9, 135, s9
  s_add_u32 s9, s9, s6
  s_cmp_ge_u32 s9, 140
  s_cbranch_scc1 L_pfd4
  s_mul_i32 s10, s9, 4682
  s_lshr_b32 s10, s10, 16
  s_mul_i32 s76, s10, 14
  s_sub_u32 s76, s9, s76
  s_cmp_ge_u32 s76, 4
  s_cbranch_scc1 L_pfu4
  s_lshl_b32 s9, s5, 2
  s_add_u32 s9, s9, s76
  s_mul_i32 s9, s9, 81920
  s_lshl_b32 s10, s10, 7
  s_add_u32 s9, s9, s10
  buffer_load_dword v23, v20, s[60:63], s9 offen
  s_branch L_pfd4
L_pfu4:
  s_mul_i32 s9, s10, 81920
  s_lshl_b32 s76, s76, 7
  s_add_u32 s9, s9, s76
  s_sub_u32 s9, s9, 512
  buffer_load_dword v23, v20, s[68:71], s9 offen
L_pfd4:
  s_add_u32 m0, s75, 20480
  s_add_u32 s74, s74, 442368
  buffer_load_dwordx4 v8, s[48:51], s74 offen offset:0  lds
  buffer_load_dwordx4 v9, s[48:51], s74 offen offset:1024  lds
  buffer_load_dwordx4 v10, s[48:51], s74 offen offset:2048  lds
  buffer_load_dwordx4 v11, s[48:51], s74 offen offset:3072  lds
  s_waitcnt vmcnt(20)
  s_cmp_ge_u32 s3, 2
  s_cbranch_scc1 L_notr0
  ds_read_b64_tr_b16 a[0:1], v12 offset:0
  ds_read_b64_tr_b16 a[2:3], v12 offset:512
  ds_read_b64_tr_b16 a[4:5], v13 offset:0
  ds_read_b64_tr_b16 a[6:7], v13 offset:512
  ds_read_b64_tr_b16 a[8:9], v14 offset:0
  ds_read_b64_tr_b16 a[10:11], v14 offset:512
  ds_read_b64_tr_b16 a[12:13], v15 offset:0
  ds_read_b64_tr_b16 a[14:15], v15 offset:512
L_notr0:
  s_add_u32 m0, s75, 24576
  s_add_u32 s74, s74, 442368
  buffer_load_dwordx4 v8, s[48:51], s74 offen offset:0  lds
  buffer_load_dwordx4 v9, s[48:51], s74 offen offset:1024  lds
  buffer_load_dwordx4 v10, s[48:51], s74 offen offset:2048  lds
  buffer_load_dwordx4 v11, s[48:51], s74 offen offset:3072  lds
  s_waitcnt vmcnt(20)
  ds_read_b64_tr_b16 a[16:17], v12 offset:4096
  ds_read_b64_tr_b16 a[18:19], v12 offset:4608
  ds_read_b64_tr_b16 a[20:21], v13 offset:4096
  ds_read_b64_tr_b16 a[22:23], v13 offset:4608
  ds_read_b64_tr_b16 a[24:25], v14 offset:4096
  ds_read_b64_tr_b16 a[26:27], v14 offset:4608
  ds_read_b64_tr_b16 a[28:29], v15 offset:4096
  ds_read_b64_tr_b16 a[30:31], v15 offset:4608
  s_add_u32 m0, s75, 28672
  s_add_u32 s74, s74, 442368
  buffer_load_dwordx4 v8, s[48:51], s74 offen offset:0  lds
  buffer_load_dwordx4 v9, s[48:51], s74 offen offset:1024  lds
  buffer_load_dwordx4 v10, s[48:51], s74 offen offset:2048  lds
  buffer_load_dwordx4 v11, s[48:51], s74 offen offset:3072  lds
  s_waitcnt vmcnt(20)
  ds_read_b64_tr_b16 a[32:33], v12 offset:8192
  ds_read_b64_tr_b16 a[34:35], v12 offset:8704
  ds_read_b64_tr_b16 a[36:37], v13 offset:8192
  ds_read_b64_tr_b16 a[38:39], v13 offset:8704
  ds_read_b64_tr_b16 a[40:41], v14 offset:8192
  ds_read_b64_tr_b16 a[42:43], v14 offset:8704
  ds_read_b64_tr_b16 a[44:45], v15 offset:8192
  ds_read_b64_tr_b16 a[46:47], v15 offset:8704
  s_add_u32 m0, s75, 32768
  s_add_u32 s74, s74, 442368
  buffer_load_dwordx4 v8, s[48:51], s74 offen offset:0  lds
  buffer_load_dwordx4 v9, s[48:51], s74 offen offset:1024  lds
  buffer_load_dwordx4 v10, s[48:51], s74 offen offset:2048  lds
  buffer_load_dwordx4 v11, s[48:51], s74 offen offset:3072  lds
  s_waitcnt vmcnt(20)
  ds_read_b64_tr_b16 a[48:49], v12 offset:12288
  ds_read_b64_tr_b16 a[50:51], v12 offset:12800
  ds_read_b64_tr_b16 a[52:53], v13 offset:12288
  ds_read_b64_tr_b16 a[54:55], v13 offset:12800
  ds_read_b64_tr_b16 a[56:57], v14 offset:12288
  ds_read_b64_tr_b16 a[58:59], v14 offset:12800
  ds_read_b64_tr_b16 a[60:61], v15 offset:12288
  ds_read_b64_tr_b16 a[62:63], v15 offset:12800
  s_waitcnt lgkmcnt(8)
  s_add_u32 m0, s75, 0
  s_add_u32 s74, s74, 442368
  buffer_load_dwordx4 v8, s[48:51], s74 offen offset:0  lds
  buffer_load_dwordx4 v9, s[48:51], s74 offen offset:1024  lds
  buffer_load_dwordx4 v10, s[48:51], s74 offen offset:2048  lds
  buffer_load_dwordx4 v11, s[48:51], s74 offen offset:3072  lds
  s_waitcnt lgkmcnt(8)
  s_add_u32 m0, s75, 4096
  s_add_u32 s74, s74, 442368
  buffer_load_dwordx4 v8, s[48:51], s74 offen offset:0  lds
  buffer_load_dwordx4 v9, s[48:51], s74 offen offset:1024  lds
  buffer_load_dwordx4 v10, s[48:51], s74 offen offset:2048  lds
  buffer_load_dwordx4 v11, s[48:51], s74 offen offset:3072  lds
  s_waitcnt lgkmcnt(8)
  s_add_u32 m0, s75, 8192
  s_add_u32 s74, s74, 442368
  buffer_load_dwordx4 v8, s[48:51], s74 offen offset:0  lds
  buffer_load_dwordx4 v9, s[48:51], s74 offen offset:1024  lds
  buffer_load_dwordx4 v10, s[48:51], s74 offen offset:2048  lds
  buffer_load_dwordx4 v11, s[48:51], s74 offen offset:3072  lds
  buffer_load_dword v124, v25, s[64:67], 0 offen sc1
L_stub5:
  s_cbranch_execz L_scret
  s_waitcnt vmcnt(29)
  ds_read_b64_tr_b16 a[64:65], v12 offset:16384
  ds_read_b64_tr_b16 a[66:67], v12 offset:16896
  ds_read_b64_tr_b16 a[68:69], v13 offset:16384
  ds_read_b64_tr_b16 a[70:71], v13 offset:16896
  ds_read_b64_tr_b16 a[72:73], v14 offset:16384
  ds_read_b64_tr_b16 a[74:75], v14 offset:16896
  ds_read_b64_tr_b16 a[76:77], v15 offset:16384
  ds_read_b64_tr_b16 a[78:79], v15 offset:16896
  s_waitcnt lgkmcnt(8)
  s_add_u32 m0, s75, 12288
  s_add_u32 s74, s74, 442368
  buffer_load_dwordx4 v8, s[48:51], s74 offen offset:0  lds
  buffer_load_dwordx4 v9, s[48:51], s74 offen offset:1024  lds
  buffer_load_dwordx4 v10, s[48:51], s74 offen offset:2048  lds
  buffer_load_dwordx4 v11, s[48:51], s74 offen offset:3072  lds
  s_waitcnt vmcnt(29)
  ds_read_b64_tr_b16 a[80:81], v12 offset:20480
  ds_read_b64_tr_b16 a[82:83], v12 offset:20992
  ds_read_b64_tr_b16 a[84:85], v13 offset:20480
  ds_read_b64_tr_b16 a[86:87], v13 offset:20992
  ds_read_b64_tr_b16 a[88:89], v14 offset:20480
  ds_read_b64_tr_b16 a[90:91], v14 offset:20992
  ds_read_b64_tr_b16 a[92:93], v15 offset:20480
  ds_read_b64_tr_b16 a[94:95], v15 offset:20992
  s_waitcnt lgkmcnt(8)
  s_add_u32 m0, s75, 16384
  s_add_u32 s74, s74, 442368
  buffer_load_dwordx4 v8, s[48:51], s74 offen offset:0  lds
  buffer_load_dwordx4 v9, s[48:51], s74 offen offset:1024  lds
  buffer_load_dwordx4 v10, s[48:51], s74 offen offset:2048  lds
  buffer_load_dwordx4 v11, s[48:51], s74 offen offset:3072  lds
  s_add_u32 s56, s32, 0x240000
  s_addc_u32 s57, s33, 0
  s_and_b32 s57, s57, 0xffff
  s_mov_b32 s58, 0x230000
  s_mov_b32 s59, 0x20000
  s_waitcnt vmcnt(29)
  ds_read_b64_tr_b16 a[96:97], v12 offset:24576
  ds_read_b64_tr_b16 a[98:99], v12 offset:25088
  ds_read_b64_tr_b16 a[100:101], v13 offset:24576
  ds_read_b64_tr_b16 a[102:103], v13 offset:25088
  ds_read_b64_tr_b16 a[104:105], v14 offset:24576
  ds_read_b64_tr_b16 a[106:107], v14 offset:25088
  ds_read_b64_tr_b16 a[108:109], v15 offset:24576
  ds_read_b64_tr_b16 a[110:111], v15 offset:25088
  s_waitcnt vmcnt(25)
  ds_read_b64_tr_b16 a[112:113], v12 offset:28672
  ds_read_b64_tr_b16 a[114:115], v12 offset:29184
  ds_read_b64_tr_b16 a[116:117], v13 offset:28672
  ds_read_b64_tr_b16 a[118:119], v13 offset:29184
  ds_read_b64_tr_b16 a[120:121], v14 offset:28672
  ds_read_b64_tr_b16 a[122:123], v14 offset:29184
  ds_read_b64_tr_b16 a[124:125], v15 offset:28672
  ds_read_b64_tr_b16 a[126:127], v15 offset:29184
  s_waitcnt vmcnt(21)
  ds_read_b64_tr_b16 a[128:129], v12 offset:32768
  ds_read_b64_tr_b16 a[130:131], v12 offset:33280
  ds_read_b64_tr_b16 a[132:133], v13 offset:32768
  ds_read_b64_tr_b16 a[134:135], v13 offset:33280
  ds_read_b64_tr_b16 a[136:137], v14 offset:32768
  ds_read_b64_tr_b16 a[138:139], v14 offset:33280
  ds_read_b64_tr_b16 a[140:141], v15 offset:32768
  ds_read_b64_tr_b16 a[142:143], v15 offset:33280
  s_waitcnt vmcnt(17)
  ds_read_b64_tr_b16 a[144:145], v12 offset:0
  ds_read_b64_tr_b16 a[146:147], v12 offset:512
  ds_read_b64_tr_b16 a[148:149], v13 offset:0
  ds_read_b64_tr_b16 a[150:151], v13 offset:512
  ds_read_b64_tr_b16 a[152:153], v14 offset:0
  ds_read_b64_tr_b16 a[154:155], v14 offset:512
  ds_read_b64_tr_b16 a[156:157], v15 offset:0
  ds_read_b64_tr_b16 a[158:159], v15 offset:512
  s_waitcnt vmcnt(13)
  ds_read_b64_tr_b16 a[160:161], v12 offset:4096
  ds_read_b64_tr_b16 a[162:163], v12 offset:4608
  ds_read_b64_tr_b16 a[164:165], v13 offset:4096
  ds_read_b64_tr_b16 a[166:167], v13 offset:4608
  ds_read_b64_tr_b16 a[168:169], v14 offset:4096
  ds_read_b64_tr_b16 a[170:171], v14 offset:4608
  ds_read_b64_tr_b16 a[172:173], v15 offset:4096
  ds_read_b64_tr_b16 a[174:175], v15 offset:4608
  s_waitcnt vmcnt(9)
  ds_read_b64_tr_b16 a[176:177], v12 offset:8192
  ds_read_b64_tr_b16 a[178:179], v12 offset:8704
  ds_read_b64_tr_b16 a[180:181], v13 offset:8192
  ds_read_b64_tr_b16 a[182:183], v13 offset:8704
  ds_read_b64_tr_b16 a[184:185], v14 offset:8192
  ds_read_b64_tr_b16 a[186:187], v14 offset:8704
  ds_read_b64_tr_b16 a[188:189], v15 offset:8192
  ds_read_b64_tr_b16 a[190:191], v15 offset:8704
  s_cmp_lg_u32 s3, 0
  s_cbranch_scc1 L_nopollA
  s_waitcnt vmcnt(8)
  v_cmp_ne_u32 vcc, s4, v124
  s_cmp_eq_u64 vcc, 0
  s_cbranch_scc1 L_nopollA
  s_mov_b32 s79, 400000
L_poll0:
  buffer_load_dword v124, v25, s[64:67], 0 offen sc1
  s_waitcnt vmcnt(0)
  v_cmp_ne_u32 vcc, s4, v124
  s_cmp_eq_u64 vcc, 0
  s_cbranch_scc1 L_pollok0
  s_sleep 1
  s_sub_u32 s79, s79, 1
  s_cmp_lg_u32 s79, 0
  s_cbranch_scc1 L_poll0
L_pollok0:
L_nopollA:
  s_waitcnt lgkmcnt(8)
  s_barrier
  s_cmp_lt_u32 s3, 2
  s_cbranch_scc1 L_a0
  v_mov_b64 v[128:129], 0
  v_mov_b64 v[130:131], 0
  v_mov_b64 v[132:133], 0
  v_mov_b64 v[134:135], 0
  v_mov_b64 v[136:137], 0
  v_mov_b64 v[138:139], 0
  v_mov_b64 v[140:141], 0
  v_mov_b64 v[142:143], 0
  v_mov_b64 v[144:145], 0
  v_mov_b64 v[146:147], 0
  s_branch L_a0done
L_a0:
  buffer_load_dwordx4 v[128:131], v5, s[52:55], s11 offen offset:0 sc1
  buffer_load_dwordx4 v[132:135], v5, s[52:55], s11 offen offset:1024 sc1
  buffer_load_dwordx4 v[136:139], v5, s[52:55], s11 offen offset:2048 sc1
  buffer_load_dwordx4 v[140:143], v5, s[52:55], s11 offen offset:3072 sc1
  buffer_load_dwordx4 v[144:147], v6, s[52:55], s11 offen sc1
L_a0done:
  s_add_u32 s11, s11, 20480
  buffer_load_dwordx4 v[148:151], v5, s[52:55], s11 offen offset:0 sc1
  buffer_load_dwordx4 v[152:155], v5, s[52:55], s11 offen offset:1024 sc1
  buffer_load_dwordx4 v[156:159], v5, s[52:55], s11 offen offset:2048 sc1
  buffer_load_dwordx4 v[160:163], v5, s[52:55], s11 offen offset:3072 sc1
  buffer_load_dwordx4 v[164:167], v6, s[52:55], s11 offen sc1
L_stub6:
  s_cbranch_execz L_scret
  s_add_u32 s11, s11, 20480
  buffer_load_dwordx4 v[168:171], v5, s[52:55], s11 offen offset:0 sc1
  buffer_load_dwordx4 v[172:175], v5, s[52:55], s11 offen offset:1024 sc1
  buffer_load_dwordx4 v[176:179], v5, s[52:55], s11 offen offset:2048 sc1
  buffer_load_dwordx4 v[180:183], v5, s[52:55], s11 offen offset:3072 sc1
  buffer_load_dwordx4 v[184:187], v6, s[52:55], s11 offen sc1
  s_add_u32 s11, s11, 20480
  s_branch L_page0
.p2align 12
L_page0:
L_stub7:
  s_cbranch_execz L_scret
  s_waitcnt vmcnt(14)
  ds_read_b64_tr_b16 a[192:193], v12 offset:12288
  ds_read_b64_tr_b16 a[194:195], v12 offset:12800
  ds_read_b64_tr_b16 a[196:197], v13 offset:12288
  ds_read_b64_tr_b16 a[198:199], v13 offset:12800
  ds_read_b64_tr_b16 a[200:201], v14 offset:12288
  ds_read_b64_tr_b16 a[202:203], v14 offset:12800
  ds_read_b64_tr_b16 a[204:205], v15 offset:12288
  ds_read_b64_tr_b16 a[206:207], v15 offset:12800
  s_waitcnt vmcnt(10)
  ds_read_b64_tr_b16 a[208:209], v12 offset:16384
  ds_read_b64_tr_b16 a[210:211], v12 offset:16896
  ds_read_b64_tr_b16 a[212:213], v13 offset:16384
  ds_read_b64_tr_b16 a[214:215], v13 offset:16896
  ds_read_b64_tr_b16 a[216:217], v14 offset:16384
  ds_read_b64_tr_b16 a[218:219], v14 offset:16896
  ds_read_b64_tr_b16 a[220:221], v15 offset:16384
  ds_read_b64_tr_b16 a[222:223], v15 offset:16896
  s_waitcnt lgkmcnt(0)
  s_mov_b32 s68, s28
  s_and_b32 s69, s29, 0xffff
  s_mov_b32 s70, 0x6c0000
  s_mov_b32 s71, 0x20000
  s_waitcnt vmcnt(14)
  v_mfma_f32_16x16x32_bf16 v[16:19], v[128:131], a[0:3], 0
  v_mfma_f32_16x16x32_bf16 v[20:23], v[128:131], a[4:7], 0
  v_mfma_f32_16x16x32_bf16 v[24:27], v[128:131], a[8:11], 0
  v_mfma_f32_16x16x32_bf16 v[28:31], v[128:131], a[12:15], 0
  buffer_load_dwordx4 v[128:131], v5, s[52:55], s11 offen offset:0 sc1
  s_waitcnt vmcnt(14)
  v_mfma_f32_16x16x32_bf16 v[44:47], v[132:135], a[12:15], 0
  v_mfma_f32_16x16x32_bf16 v[40:43], v[132:135], a[8:11], 0
  v_mfma_f32_16x16x32_bf16 v[36:39], v[132:135], a[4:7], 0
  v_mfma_f32_16x16x32_bf16 v[32:35], v[132:135], a[0:3], 0
  buffer_load_dwordx4 v[132:135], v5, s[52:55], s11 offen offset:1024 sc1
  s_waitcnt vmcnt(14)
  v_mfma_f32_16x16x32_bf16 v[48:51], v[136:139], a[0:3], 0
  v_mfma_f32_16x16x32_bf16 v[52:55], v[136:139], a[4:7], 0
  v_mfma_f32_16x16x32_bf16 v[56:59], v[136:139], a[8:11], 0
  v_mfma_f32_16x16x32_bf16 v[60:63], v[136:139], a[12:15], 0
  buffer_load_dwordx4 v[136:139], v5, s[52:55], s11 offen offset:2048 sc1
  s_waitcnt vmcnt(14)
  v_mfma_f32_16x16x32_bf16 v[76:79], v[140:143], a[12:15], 0
  v_mfma_f32_16x16x32_bf16 v[72:75], v[140:143], a[8:11], 0
  v_mfma_f32_16x16x32_bf16 v[68:71], v[140:143], a[4:7], 0
  v_mfma_f32_16x16x32_bf16 v[64:67], v[140:143], a[0:3], 0
  buffer_load_dwordx4 v[140:143], v5, s[52:55], s11 offen offset:3072 sc1
  s_waitcnt vmcnt(14)
  v_mfma_f32_16x16x32_bf16 v[80:83], v[144:147], a[0:3], 0
  v_mfma_f32_16x16x32_bf16 v[84:87], v[144:147], a[4:7], 0
  v_mfma_f32_16x16x32_bf16 v[88:91], v[144:147], a[8:11], 0
  v_mfma_f32_16x16x32_bf16 v[92:95], v[144:147], a[12:15], 0
  buffer_load_dwordx4 v[144:147], v6, s[52:55], s11 offen sc1
  s_add_u32 s11, s11, 20480
  s_waitcnt vmcnt(14)
  v_mfma_f32_16x16x32_bf16 v[16:19], v[148:151], a[16:19], v[16:19]
  v_mfma_f32_16x16x32_bf16 v[20:23], v[148:151], a[20:23], v[20:23]
  v_mfma_f32_16x16x32_bf16 v[24:27], v[148:151], a[24:27], v[24:27]
  v_mfma_f32_16x16x32_bf16 v[28:31], v[148:151], a[28:31], v[28:31]
  buffer_load_dwordx4 v[148:151], v5, s[52:55], s11 offen offset:0 sc1
  s_waitcnt vmcnt(14)
  v_mfma_f32_16x16x32_bf16 v[44:47], v[152:155], a[28:31], v[44:47]
  v_mfma_f32_16x16x32_bf16 v[40:43], v[152:155], a[24:27], v[40:43]
  v_mfma_f32_16x16x32_bf16 v[36:39], v[152:155], a[20:23], v[36:39]
  v_mfma_f32_16x16x32_bf16 v[32:35], v[152:155], a[16:19], v[32:35]
  buffer_load_dwordx4 v[152:155], v5, s[52:55], s11 offen offset:1024 sc1
  s_waitcnt vmcnt(14)
  v_mfma_f32_16x16x32_bf16 v[48:51], v[156:159], a[16:19], v[48:51]
  v_mfma_f32_16x16x32_bf16 v[52:55], v[156:159], a[20:23], v[52:55]
  v_mfma_f32_16x16x32_bf16 v[56:59], v[156:159], a[24:27], v[56:59]
  v_mfma_f32_16x16x32_bf16 v[60:63], v[156:159], a[28:31], v[60:63]
  buffer_load_dwordx4 v[156:159], v5, s[52:55], s11 offen offset:2048 sc1
  s_waitcnt vmcnt(14)
  v_mfma_f32_16x16x32_bf16 v[76:79], v[160:163], a[28:31], v[76:79]
  v_mfma_f32_16x16x32_bf16 v[72:75], v[160:163], a[24:27], v[72:75]
  v_mfma_f32_16x16x32_bf16 v[68:71], v[160:163], a[20:23], v[68:71]
  v_mfma_f32_16x16x32_bf16 v[64:67], v[160:163], a[16:19], v[64:67]
  buffer_load_dwordx4 v[160:163], v5, s[52:55], s11 offen offset:3072 sc1
  s_waitcnt vmcnt(14)
  v_mfma_f32_16x16x32_bf16 v[80:83], v[164:167], a[16:19], v[80:83]
  v_mfma_f32_16x16x32_bf16 v[84:87], v[164:167], a[20:23], v[84:87]
  v_mfma_f32_16x16x32_bf16 v[88:91], v[164:167], a[24:27], v[88:91]
  v_mfma_f32_16x16x32_bf16 v[92:95], v[164:167], a[28:31], v[92:95]
  buffer_load_dwordx4 v[164:167], v6, s[52:55], s11 offen sc1
  s_add_u32 s11, s11, 20480
  s_waitcnt vmcnt(14)
  v_mfma_f32_16x16x32_bf16 v[16:19], v[168:171], a[32:35], v[16:19]
  v_mfma_f32_16x16x32_bf16 v[20:23], v[168:171], a[36:39], v[20:23]
  v_mfma_f32_16x16x32_bf16 v[24:27], v[168:171], a[40:43], v[24:27]
  v_mfma_f32_16x16x32_bf16 v[28:31], v[168:171], a[44:47], v[28:31]
  buffer_load_dwordx4 v[168:171], v5, s[52:55], s11 offen offset:0 sc1
  s_waitcnt vmcnt(14)
  v_mfma_f32_16x16x32_bf16 v[44:47], v[172:175], a[44:47], v[44:47]
  v_mfma_f32_16x16x32_bf16 v[40:43], v[172:175], a[40:43], v[40:43]
  v_mfma_f32_16x16x32_bf16 v[36:39], v[172:175], a[36:39], v[36:39]
  v_mfma_f32_16x16x32_bf16 v[32:35], v[172:175], a[32:35], v[32:35]
  buffer_load_dwordx4 v[172:175], v5, s[52:55], s11 offen offset:1024 sc1
  s_waitcnt vmcnt(14)
  v_mfma_f32_16x16x32_bf16 v[48:51], v[176:179], a[32:35], v[48:51]
  v_mfma_f32_16x16x32_bf16 v[52:55], v[176:179], a[36:39], v[52:55]
  v_mfma_f32_16x16x32_bf16 v[56:59], v[176:179], a[40:43], v[56:59]
  v_mfma_f32_16x16x32_bf16 v[60:63], v[176:179], a[44:47], v[60:63]
  buffer_load_dwordx4 v[176:179], v5, s[52:55], s11 offen offset:2048 sc1
  s_waitcnt vmcnt(14)
  v_mfma_f32_16x16x32_bf16 v[76:79], v[180:183], a[44:47], v[76:79]
  v_mfma_f32_16x16x32_bf16 v[72:75], v[180:183], a[40:43], v[72:75]
  v_mfma_f32_16x16x32_bf16 v[68:71], v[180:183], a[36:39], v[68:71]
  v_mfma_f32_16x16x32_bf16 v[64:67], v[180:183], a[32:35], v[64:67]
  buffer_load_dwordx4 v[180:183], v5, s[52:55], s11 offen offset:3072 sc1
  s_waitcnt vmcnt(14)
  v_mfma_f32_16x16x32_bf16 v[80:83], v[184:187], a[32:35], v[80:83]
  v_mfma_f32_16x16x32_bf16 v[84:87], v[184:187], a[36:39], v[84:87]
  v_mfma_f32_16x16x32_bf16 v[88:91], v[184:187], a[40:43], v[88:91]
  v_mfma_f32_16x16x32_bf16 v[92:95], v[184:187], a[44:47], v[92:95]
  buffer_load_dwordx4 v[184:187], v6, s[52:55], s11 offen sc1
  s_add_u32 s11, s11, 20480
  s_waitcnt vmcnt(14)
  v_mfma_f32_16x16x32_bf16 v[16:19], v[128:131], a[48:51], v[16:19]
  v_mfma_f32_16x16x32_bf16 v[20:23], v[128:131], a[52:55], v[20:23]
  v_mfma_f32_16x16x32_bf16 v[24:27], v[128:131], a[56:59], v[24:27]
  v_mfma_f32_16x16x32_bf16 v[28:31], v[128:131], a[60:63], v[28:31]
  buffer_load_dwordx4 v[128:131], v5, s[52:55], s11 offen offset:0 sc1
  s_waitcnt vmcnt(14)
L_stub8:
  s_cbranch_execz L_scret
  v_mfma_f32_16x16x32_bf16 v[44:47], v[132:135], a[60:63], v[44:47]
  v_mfma_f32_16x16x32_bf16 v[40:43], v[132:135], a[56:59], v[40:43]
  v_mfma_f32_16x16x32_bf16 v[36:39], v[132:135], a[52:55], v[36:39]
  v_mfma_f32_16x16x32_bf16 v[32:35], v[132:135], a[48:51], v[32:35]
  buffer_load_dwordx4 v[132:135], v5, s[52:55], s11 offen offset:1024 sc1
  s_waitcnt vmcnt(14)
  v_mfma_f32_16x16x32_bf16 v[48:51], v[136:139], a[48:51], v[48:51]
  v_mfma_f32_16x16x32_bf16 v[52:55], v[136:139], a[52:55], v[52:55]
  v_mfma_f32_16x16x32_bf16 v[56:59], v[136:139], a[56:59], v[56:59]
  v_mfma_f32_16x16x32_bf16 v[60:63], v[136:139], a[60:63], v[60:63]
  buffer_load_dwordx4 v[136:139], v5, s[52:55], s11 offen offset:2048 sc1
  s_waitcnt vmcnt(14)
  v_mfma_f32_16x16x32_bf16 v[76:79], v[140:143], a[60:63], v[76:79]
  v_mfma_f32_16x16x32_bf16 v[72:75], v[140:143], a[56:59], v[72:75]
  v_mfma_f32_16x16x32_bf16 v[68:71], v[140:143], a[52:55], v[68:71]
  v_mfma_f32_16x16x32_bf16 v[64:67], v[140:143], a[48:51], v[64:67]
  buffer_load_dwordx4 v[140:143], v5, s[52:55], s11 offen offset:3072 sc1
  s_waitcnt vmcnt(14)
  v_mfma_f32_16x16x32_bf16 v[80:83], v[144:147], a[48:51], v[80:83]
  v_mfma_f32_16x16x32_bf16 v[84:87], v[144:147], a[52:55], v[84:87]
  v_mfma_f32_16x16x32_bf16 v[88:91], v[144:147], a[56:59], v[88:91]
  v_mfma_f32_16x16x32_bf16 v[92:95], v[144:147], a[60:63], v[92:95]
  buffer_load_dwordx4 v[144:147], v6, s[52:55], s11 offen sc1
  s_add_u32 s11, s11, 20480
  s_waitcnt vmcnt(14)
  v_mfma_f32_16x16x32_bf16 v[16:19], v[148:151], a[64:67], v[16:19]
  v_mfma_f32_16x16x32_bf16 v[20:23], v[148:151], a[68:71], v[20:23]
  v_mfma_f32_16x16x32_bf16 v[24:27], v[148:151], a[72:75], v[24:27]
  v_mfma_f32_16x16x32_bf16 v[28:31], v[148:151], a[76:79], v[28:31]
  buffer_load_dwordx4 v[148:151], v5, s[52:55], s11 offen offset:0 sc1
  s_waitcnt vmcnt(14)
  v_mfma_f32_16x16x32_bf16 v[44:47], v[152:155], a[76:79], v[44:47]
  v_mfma_f32_16x16x32_bf16 v[40:43], v[152:155], a[72:75], v[40:43]
  v_mfma_f32_16x16x32_bf16 v[36:39], v[152:155], a[68:71], v[36:39]
  v_mfma_f32_16x16x32_bf16 v[32:35], v[152:155], a[64:67], v[32:35]
  buffer_load_dwordx4 v[152:155], v5, s[52:55], s11 offen offset:1024 sc1
  s_waitcnt vmcnt(14)
  v_mfma_f32_16x16x32_bf16 v[48:51], v[156:159], a[64:67], v[48:51]
  v_mfma_f32_16x16x32_bf16 v[52:55], v[156:159], a[68:71], v[52:55]
  v_mfma_f32_16x16x32_bf16 v[56:59], v[156:159], a[72:75], v[56:59]
  v_mfma_f32_16x16x32_bf16 v[60:63], v[156:159], a[76:79], v[60:63]
  buffer_load_dwordx4 v[156:159], v5, s[52:55], s11 offen offset:2048 sc1
  s_waitcnt vmcnt(14)
  v_mfma_f32_16x16x32_bf16 v[76:79], v[160:163], a[76:79], v[76:79]
  v_mfma_f32_16x16x32_bf16 v[72:75], v[160:163], a[72:75], v[72:75]
  v_mfma_f32_16x16x32_bf16 v[68:71], v[160:163], a[68:71], v[68:71]
  v_mfma_f32_16x16x32_bf16 v[64:67], v[160:163], a[64:67], v[64:67]
  buffer_load_dwordx4 v[160:163], v5, s[52:55], s11 offen offset:3072 sc1
  s_waitcnt vmcnt(14)
  v_mfma_f32_16x16x32_bf16 v[80:83], v[164:167], a[64:67], v[80:83]
  v_mfma_f32_16x16x32_bf16 v[84:87], v[164:167], a[68:71], v[84:87]
  v_mfma_f32_16x16x32_bf16 v[88:91], v[164:167], a[72:75], v[88:91]
  v_mfma_f32_16x16x32_bf16 v[92:95], v[164:167], a[76:79], v[92:95]
  buffer_load_dwordx4 v[164:167], v6, s[52:55], s11 offen sc1
  s_add_u32 s11, s11, 20480
  s_waitcnt vmcnt(14)
  v_mfma_f32_16x16x32_bf16 v[16:19], v[168:171], a[80:83], v[16:19]
  v_mfma_f32_16x16x32_bf16 v[20:23], v[168:171], a[84:87], v[20:23]
  v_mfma_f32_16x16x32_bf16 v[24:27], v[168:171], a[88:91], v[24:27]
  v_mfma_f32_16x16x32_bf16 v[28:31], v[168:171], a[92:95], v[28:31]
  buffer_load_dwordx4 v[168:171], v5, s[52:55], s11 offen offset:0 sc1
  s_waitcnt vmcnt(14)
  v_mfma_f32_16x16x32_bf16 v[44:47], v[172:175], a[92:95], v[44:47]
  v_mfma_f32_16x16x32_bf16 v[40:43], v[172:175], a[88:91], v[40:43]
  v_mfma_f32_16x16x32_bf16 v[36:39], v[172:175], a[84:87], v[36:39]
  v_mfma_f32_16x16x32_bf16 v[32:35], v[172:175], a[80:83], v[32:35]
  buffer_load_dwordx4 v[172:175], v5, s[52:55], s11 offen offset:1024 sc1
  s_waitcnt vmcnt(14)
  v_mfma_f32_16x16x32_bf16 v[48:51], v[176:179], a[80:83], v[48:51]
  v_mfma_f32_16x16x32_bf16 v[52:55], v[176:179], a[84:87], v[52:55]
  v_mfma_f32_16x16x32_bf16 v[56:59], v[176:179], a[88:91], v[56:59]
  v_mfma_f32_16x16x32_bf16 v[60:63], v[176:179], a[92:95], v[60:63]
  buffer_load_dwordx4 v[176:179], v5, s[52:55], s11 offen offset:2048 sc1
  s_waitcnt vmcnt(14)
  v_mfma_f32_16x16x32_bf16 v[76:79], v[180:183], a[92:95], v[76:79]
  v_mfma_f32_16x16x32_bf16 v[72:75], v[180:183], a[88:91], v[72:75]
  v_mfma_f32_16x16x32_bf16 v[68:71], v[180:183], a[84:87], v[68:71]
  v_mfma_f32_16x16x32_bf16 v[64:67], v[180:183], a[80:83], v[64:67]
  buffer_load_dwordx4 v[180:183], v5, s[52:55], s11 offen offset:3072 sc1
  s_waitcnt vmcnt(14)
  v_mfma_f32_16x16x32_bf16 v[80:83], v[184:187], a[80:83], v[80:83]
  v_mfma_f32_16x16x32_bf16 v[84:87], v[184:187], a[84:87], v[84:87]
  v_mfma_f32_16x16x32_bf16 v[88:91], v[184:187], a[88:91], v[88:91]
  v_mfma_f32_16x16x32_bf16 v[92:95], v[184:187], a[92:95], v[92:95]
  buffer_load_dwordx4 v[184:187], v6, s[52:55], s11 offen sc1
  s_add_u32 s11, s11, 20480
  s_waitcnt vmcnt(14)
  v_mfma_f32_16x16x32_bf16 v[16:19], v[128:131], a[96:99], v[16:19]
  v_mfma_f32_16x16x32_bf16 v[20:23], v[128:131], a[100:103], v[20:23]
  v_mfma_f32_16x16x32_bf16 v[24:27], v[128:131], a[104:107], v[24:27]
  v_mfma_f32_16x16x32_bf16 v[28:31], v[128:131], a[108:111], v[28:31]
  buffer_load_dwordx4 v[128:131], v5, s[52:55], s11 offen offset:0 sc1
  s_waitcnt vmcnt(14)
  v_mfma_f32_16x16x32_bf16 v[44:47], v[132:135], a[108:111], v[44:47]
  v_mfma_f32_16x16x32_bf16 v[40:43], v[132:135], a[104:107], v[40:43]
  v_mfma_f32_16x16x32_bf16 v[36:39], v[132:135], a[100:103], v[36:39]
  v_mfma_f32_16x16x32_bf16 v[32:35], v[132:135], a[96:99], v[32:35]
  buffer_load_dwordx4 v[132:135], v5, s[52:55], s11 offen offset:1024 sc1
  s_waitcnt vmcnt(14)
  v_mfma_f32_16x16x32_bf16 v[48:51], v[136:139], a[96:99], v[48:51]
  v_mfma_f32_16x16x32_bf16 v[52:55], v[136:139], a[100:103], v[52:55]
  v_mfma_f32_16x16x32_bf16 v[56:59], v[136:139], a[104:107], v[56:59]
  v_mfma_f32_16x16x32_bf16 v[60:63], v[136:139], a[108:111], v[60:63]
  buffer_load_dwordx4 v[136:139], v5, s[52:55], s11 offen offset:2048 sc1
  s_waitcnt vmcnt(14)
  v_mfma_f32_16x16x32_bf16 v[76:79], v[140:143], a[108:111], v[76:79]
  v_mfma_f32_16x16x32_bf16 v[72:75], v[140:143], a[104:107], v[72:75]
  v_mfma_f32_16x16x32_bf16 v[68:71], v[140:143], a[100:103], v[68:71]
  v_mfma_f32_16x16x32_bf16 v[64:67], v[140:143], a[96:99], v[64:67]
  buffer_load_dwordx4 v[140:143], v5, s[52:55], s11 offen offset:3072 sc1
  s_waitcnt vmcnt(14)
  v_mfma_f32_16x16x32_bf16 v[80:83], v[144:147], a[96:99], v[80:83]
  v_mfma_f32_16x16x32_bf16 v[84:87], v[144:147], a[100:103], v[84:87]
  v_mfma_f32_16x16x32_bf16 v[88:91], v[144:147], a[104:107], v[88:91]
  v_mfma_f32_16x16x32_bf16 v[92:95], v[144:147], a[108:111], v[92:95]
  buffer_load_dwordx4 v[144:147], v6, s[52:55], s11 offen sc1
  s_add_u32 s11, s11, 20480
  s_waitcnt vmcnt(14)
  v_mfma_f32_16x16x32_bf16 v[16:19], v[148:151], a[112:115], v[16:19]
  v_mfma_f32_16x16x32_bf16 v[20:23], v[148:151], a[116:119], v[20:23]
  v_mfma_f32_16x16x32_bf16 v[24:27], v[148:151], a[120:123], v[24:27]
  v_mfma_f32_16x16x32_bf16 v[28:31], v[148:151], a[124:127], v[28:31]
L_stub9:
  s_cbranch_execz L_scret
  buffer_load_dwordx4 v[148:151], v5, s[52:55], s11 offen offset:0 sc1
  s_waitcnt vmcnt(14)
  v_mfma_f32_16x16x32_bf16 v[44:47], v[152:155], a[124:127], v[44:47]
  v_mfma_f32_16x16x32_bf16 v[40:43], v[152:155], a[120:123], v[40:43]
  v_mfma_f32_16x16x32_bf16 v[36:39], v[152:155], a[116:119], v[36:39]
  v_mfma_f32_16x16x32_bf16 v[32:35], v[152:155], a[112:115], v[32:35]
  buffer_load_dwordx4 v[152:155], v5, s[52:55], s11 offen offset:1024 sc1
  s_waitcnt vmcnt(14)
  v_mfma_f32_16x16x32_bf16 v[48:51], v[156:159], a[112:115], v[48:51]
  v_mfma_f32_16x16x32_bf16 v[52:55], v[156:159], a[116:119], v[52:55]
  v_mfma_f32_16x16x32_bf16 v[56:59], v[156:159], a[120:123], v[56:59]
  v_mfma_f32_16x16x32_bf16 v[60:63], v[156:159], a[124:127], v[60:63]
  buffer_load_dwordx4 v[156:159], v5, s[52:55], s11 offen offset:2048 sc1
  s_waitcnt vmcnt(14)
  v_mfma_f32_16x16x32_bf16 v[76:79], v[160:163], a[124:127], v[76:79]
  v_mfma_f32_16x16x32_bf16 v[72:75], v[160:163], a[120:123], v[72:75]
  v_mfma_f32_16x16x32_bf16 v[68:71], v[160:163], a[116:119], v[68:71]
  v_mfma_f32_16x16x32_bf16 v[64:67], v[160:163], a[112:115], v[64:67]
  buffer_load_dwordx4 v[160:163], v5, s[52:55], s11 offen offset:3072 sc1
  s_waitcnt vmcnt(14)
  v_mfma_f32_16x16x32_bf16 v[80:83], v[164:167], a[112:115], v[80:83]
  v_mfma_f32_16x16x32_bf16 v[84:87], v[164:167], a[116:119], v[84:87]
  v_mfma_f32_16x16x32_bf16 v[88:91], v[164:167], a[120:123], v[88:91]
  v_mfma_f32_16x16x32_bf16 v[92:95], v[164:167], a[124:127], v[92:95]
  buffer_load_dwordx4 v[164:167], v6, s[52:55], s11 offen sc1
  s_add_u32 s11, s11, 20480
  s_waitcnt vmcnt(14)
  v_mfma_f32_16x16x32_bf16 v[16:19], v[168:171], a[128:131], v[16:19]
  v_mfma_f32_16x16x32_bf16 v[20:23], v[168:171], a[132:135], v[20:23]
  v_mfma_f32_16x16x32_bf16 v[24:27], v[168:171], a[136:139], v[24:27]
  v_mfma_f32_16x16x32_bf16 v[28:31], v[168:171], a[140:143], v[28:31]
  buffer_load_dwordx4 v[168:171], v5, s[52:55], s11 offen offset:0 sc1
  s_waitcnt vmcnt(14)
  v_mfma_f32_16x16x32_bf16 v[44:47], v[172:175], a[140:143], v[44:47]
  v_mfma_f32_16x16x32_bf16 v[40:43], v[172:175], a[136:139], v[40:43]
  v_mfma_f32_16x16x32_bf16 v[36:39], v[172:175], a[132:135], v[36:39]
  v_mfma_f32_16x16x32_bf16 v[32:35], v[172:175], a[128:131], v[32:35]
  buffer_load_dwordx4 v[172:175], v5, s[52:55], s11 offen offset:1024 sc1
  s_waitcnt vmcnt(14)
  v_mfma_f32_16x16x32_bf16 v[48:51], v[176:179], a[128:131], v[48:51]
  v_mfma_f32_16x16x32_bf16 v[52:55], v[176:179], a[132:135], v[52:55]
  v_mfma_f32_16x16x32_bf16 v[56:59], v[176:179], a[136:139], v[56:59]
  v_mfma_f32_16x16x32_bf16 v[60:63], v[176:179], a[140:143], v[60:63]
  buffer_load_dwordx4 v[176:179], v5, s[52:55], s11 offen offset:2048 sc1
  s_waitcnt vmcnt(14)
  v_mfma_f32_16x16x32_bf16 v[76:79], v[180:183], a[140:143], v[76:79]
  v_mfma_f32_16x16x32_bf16 v[72:75], v[180:183], a[136:139], v[72:75]
  v_mfma_f32_16x16x32_bf16 v[68:71], v[180:183], a[132:135], v[68:71]
  v_mfma_f32_16x16x32_bf16 v[64:67], v[180:183], a[128:131], v[64:67]
  buffer_load_dwordx4 v[180:183], v5, s[52:55], s11 offen offset:3072 sc1
  s_waitcnt vmcnt(14)
  v_mfma_f32_16x16x32_bf16 v[80:83], v[184:187], a[128:131], v[80:83]
  v_mfma_f32_16x16x32_bf16 v[84:87], v[184:187], a[132:135], v[84:87]
  v_mfma_f32_16x16x32_bf16 v[88:91], v[184:187], a[136:139], v[88:91]
  v_mfma_f32_16x16x32_bf16 v[92:95], v[184:187], a[140:143], v[92:95]
  buffer_load_dwordx4 v[184:187], v6, s[52:55], s11 offen sc1
  s_add_u32 s11, s11, 20480
  s_waitcnt vmcnt(14)
  v_mfma_f32_16x16x32_bf16 v[16:19], v[128:131], a[144:147], v[16:19]
  v_mfma_f32_16x16x32_bf16 v[20:23], v[128:131], a[148:151], v[20:23]
  v_mfma_f32_16x16x32_bf16 v[24:27], v[128:131], a[152:155], v[24:27]
  v_mfma_f32_16x16x32_bf16 v[28:31], v[128:131], a[156:159], v[28:31]
  buffer_load_dwordx4 v[128:131], v5, s[52:55], s11 offen offset:0 sc1
  s_waitcnt vmcnt(14)
  v_mfma_f32_16x16x32_bf16 v[44:47], v[132:135], a[156:159], v[44:47]
  v_mfma_f32_16x16x32_bf16 v[40:43], v[132:135], a[152:155], v[40:43]
  v_mfma_f32_16x16x32_bf16 v[36:39], v[132:135], a[148:151], v[36:39]
  v_mfma_f32_16x16x32_bf16 v[32:35], v[132:135], a[144:147], v[32:35]
  buffer_load_dwordx4 v[132:135], v5, s[52:55], s11 offen offset:1024 sc1
  s_waitcnt vmcnt(14)
  v_mfma_f32_16x16x32_bf16 v[48:51], v[136:139], a[144:147], v[48:51]
  v_mfma_f32_16x16x32_bf16 v[52:55], v[136:139], a[148:151], v[52:55]
  v_mfma_f32_16x16x32_bf16 v[56:59], v[136:139], a[152:155], v[56:59]
  v_mfma_f32_16x16x32_bf16 v[60:63], v[136:139], a[156:159], v[60:63]
  buffer_load_dwordx4 v[136:139], v5, s[52:55], s11 offen offset:2048 sc1
  s_waitcnt vmcnt(14)
  v_mfma_f32_16x16x32_bf16 v[76:79], v[140:143], a[156:159], v[76:79]
  v_mfma_f32_16x16x32_bf16 v[72:75], v[140:143], a[152:155], v[72:75]
  v_mfma_f32_16x16x32_bf16 v[68:71], v[140:143], a[148:151], v[68:71]
  v_mfma_f32_16x16x32_bf16 v[64:67], v[140:143], a[144:147], v[64:67]
  buffer_load_dwordx4 v[140:143], v5, s[52:55], s11 offen offset:3072 sc1
  s_waitcnt vmcnt(14)
  v_mfma_f32_16x16x32_bf16 v[80:83], v[144:147], a[144:147], v[80:83]
  v_mfma_f32_16x16x32_bf16 v[84:87], v[144:147], a[148:151], v[84:87]
  v_mfma_f32_16x16x32_bf16 v[88:91], v[144:147], a[152:155], v[88:91]
  v_mfma_f32_16x16x32_bf16 v[92:95], v[144:147], a[156:159], v[92:95]
  buffer_load_dwordx4 v[144:147], v6, s[52:55], s11 offen sc1
  s_add_u32 s11, s11, 20480
  s_waitcnt vmcnt(14)
  v_mfma_f32_16x16x32_bf16 v[16:19], v[148:151], a[160:163], v[16:19]
  v_mfma_f32_16x16x32_bf16 v[20:23], v[148:151], a[164:167], v[20:23]
  v_mfma_f32_16x16x32_bf16 v[24:27], v[148:151], a[168:171], v[24:27]
  v_mfma_f32_16x16x32_bf16 v[28:31], v[148:151], a[172:175], v[28:31]
  buffer_load_dwordx4 v[148:151], v5, s[52:55], s11 offen offset:0 sc1
  s_waitcnt vmcnt(14)
  v_mfma_f32_16x16x32_bf16 v[44:47], v[152:155], a[172:175], v[44:47]
  v_mfma_f32_16x16x32_bf16 v[40:43], v[152:155], a[168:171], v[40:43]
  v_mfma_f32_16x16x32_bf16 v[36:39], v[152:155], a[164:167], v[36:39]
  v_mfma_f32_16x16x32_bf16 v[32:35], v[152:155], a[160:163], v[32:35]
  buffer_load_dwordx4 v[152:155], v5, s[52:55], s11 offen offset:1024 sc1
  s_waitcnt vmcnt(14)
  v_mfma_f32_16x16x32_bf16 v[48:51], v[156:159], a[160:163], v[48:51]
  v_mfma_f32_16x16x32_bf16 v[52:55], v[156:159], a[164:167], v[52:55]
  v_mfma_f32_16x16x32_bf16 v[56:59], v[156:159], a[168:171], v[56:59]
  v_mfma_f32_16x16x32_bf16 v[60:63], v[156:159], a[172:175], v[60:63]
  buffer_load_dwordx4 v[156:159], v5, s[52:55], s11 offen offset:2048 sc1
  s_waitcnt vmcnt(14)
  v_mfma_f32_16x16x32_bf16 v[76:79], v[160:163], a[172:175], v[76:79]
  v_mfma_f32_16x16x32_bf16 v[72:75], v[160:163], a[168:171], v[72:75]
  v_mfma_f32_16x16x32_bf16 v[68:71], v[160:163], a[164:167], v[68:71]
  v_mfma_f32_16x16x32_bf16 v[64:67], v[160:163], a[160:163], v[64:67]
  buffer_load_dwordx4 v[160:163], v5, s[52:55], s11 offen offset:3072 sc1
  s_waitcnt vmcnt(14)
  v_mfma_f32_16x16x32_bf16 v[80:83], v[164:167], a[160:163], v[80:83]
  v_mfma_f32_16x16x32_bf16 v[84:87], v[164:167], a[164:167], v[84:87]
  v_mfma_f32_16x16x32_bf16 v[88:91], v[164:167], a[168:171], v[88:91]
  v_mfma_f32_16x16x32_bf16 v[92:95], v[164:167], a[172:175], v[92:95]
  buffer_load_dwordx4 v[164:167], v6, s[52:55], s11 offen sc1
  s_waitcnt vmcnt(14)
  v_mfma_f32_16x16x32_bf16 v[16:19], v[168:171], a[176:179], v[16:19]
  v_mfma_f32_16x16x32_bf16 v[20:23], v[168:171], a[180:183], v[20:23]
  v_mfma_f32_16x16x32_bf16 v[24:27], v[168:171], a[184:187], v[24:27]
  v_mfma_f32_16x16x32_bf16 v[28:31], v[168:171], a[188:191], v[28:31]
L_stub10:
  s_cbranch_execz L_scret
  s_waitcnt vmcnt(13)
  v_mfma_f32_16x16x32_bf16 v[44:47], v[172:175], a[188:191], v[44:47]
  v_mfma_f32_16x16x32_bf16 v[40:43], v[172:175], a[184:187], v[40:43]
  v_mfma_f32_16x16x32_bf16 v[36:39], v[172:175], a[180:183], v[36:39]
  v_mfma_f32_16x16x32_bf16 v[32:35], v[172:175], a[176:179], v[32:35]
  s_waitcnt vmcnt(12)
  v_mfma_f32_16x16x32_bf16 v[48:51], v[176:179], a[176:179], v[48:51]
  v_mfma_f32_16x16x32_bf16 v[52:55], v[176:179], a[180:183], v[52:55]
  v_mfma_f32_16x16x32_bf16 v[56:59], v[176:179], a[184:187], v[56:59]
  v_mfma_f32_16x16x32_bf16 v[60:63], v[176:179], a[188:191], v[60:63]
  s_waitcnt vmcnt(11)
  v_mfma_f32_16x16x32_bf16 v[76:79], v[180:183], a[188:191], v[76:79]
  v_mfma_f32_16x16x32_bf16 v[72:75], v[180:183], a[184:187], v[72:75]
  v_mfma_f32_16x16x32_bf16 v[68:71], v[180:183], a[180:183], v[68:71]
  v_mfma_f32_16x16x32_bf16 v[64:67], v[180:183], a[176:179], v[64:67]
  s_waitcnt vmcnt(10)
  v_mfma_f32_16x16x32_bf16 v[80:83], v[184:187], a[176:179], v[80:83]
  v_mfma_f32_16x16x32_bf16 v[84:87], v[184:187], a[180:183], v[84:87]
  v_mfma_f32_16x16x32_bf16 v[88:91], v[184:187], a[184:187], v[88:91]
  v_mfma_f32_16x16x32_bf16 v[92:95], v[184:187], a[188:191], v[92:95]
  s_waitcnt vmcnt(9)
  v_mfma_f32_16x16x32_bf16 v[20:23], v[128:131], a[196:199], v[20:23]
  s_waitcnt vmcnt(8)
  v_mfma_f32_16x16x32_bf16 v[36:39], v[132:135], a[196:199], v[36:39]
  s_waitcnt vmcnt(7)
  v_mfma_f32_16x16x32_bf16 v[52:55], v[136:139], a[196:199], v[52:55]
  s_waitcnt vmcnt(6)
  v_mfma_f32_16x16x32_bf16 v[68:71], v[140:143], a[196:199], v[68:71]
  s_waitcnt vmcnt(5)
  v_mfma_f32_16x16x32_bf16 v[84:87], v[144:147], a[196:199], v[84:87]
  s_waitcnt vmcnt(4)
  v_mfma_f32_16x16x32_bf16 v[20:23], v[148:151], a[212:215], v[20:23]
  s_waitcnt vmcnt(3)
  v_mfma_f32_16x16x32_bf16 v[36:39], v[152:155], a[212:215], v[36:39]
  s_waitcnt vmcnt(2)
  v_mfma_f32_16x16x32_bf16 v[52:55], v[156:159], a[212:215], v[52:55]
  s_waitcnt vmcnt(1)
  v_mfma_f32_16x16x32_bf16 v[68:71], v[160:163], a[212:215], v[68:71]
  s_waitcnt vmcnt(0)
  v_mfma_f32_16x16x32_bf16 v[84:87], v[164:167], a[212:215], v[84:87]
  v_mfma_f32_16x16x32_bf16 v[24:27], v[128:131], a[200:203], v[24:27]
  v_mfma_f32_16x16x32_bf16 v[40:43], v[132:135], a[200:203], v[40:43]
  ds_write_b128 v121, v[20:23] offset:0
  v_mfma_f32_16x16x32_bf16 v[56:59], v[136:139], a[200:203], v[56:59]
  v_mfma_f32_16x16x32_bf16 v[72:75], v[140:143], a[200:203], v[72:75]
  ds_write_b128 v121, v[36:39] offset:1024
  v_mfma_f32_16x16x32_bf16 v[88:91], v[144:147], a[200:203], v[88:91]
  v_mfma_f32_16x16x32_bf16 v[24:27], v[148:151], a[216:219], v[24:27]
  ds_write_b128 v121, v[52:55] offset:2048
  v_mfma_f32_16x16x32_bf16 v[40:43], v[152:155], a[216:219], v[40:43]
  v_mfma_f32_16x16x32_bf16 v[56:59], v[156:159], a[216:219], v[56:59]
  ds_write_b128 v121, v[68:71] offset:3072
  v_mfma_f32_16x16x32_bf16 v[72:75], v[160:163], a[216:219], v[72:75]
  v_mfma_f32_16x16x32_bf16 v[88:91], v[164:167], a[216:219], v[88:91]
  ds_write_b128 v121, v[84:87] offset:4096
  v_mfma_f32_16x16x32_bf16 v[28:31], v[128:131], a[204:207], v[28:31]
  v_mfma_f32_16x16x32_bf16 v[44:47], v[132:135], a[204:207], v[44:47]
  ds_write_b128 v122, v[24:27] offset:5120
  v_mfma_f32_16x16x32_bf16 v[60:63], v[136:139], a[204:207], v[60:63]
  v_mfma_f32_16x16x32_bf16 v[76:79], v[140:143], a[204:207], v[76:79]
  ds_write_b128 v122, v[40:43] offset:6144
  v_mfma_f32_16x16x32_bf16 v[92:95], v[144:147], a[204:207], v[92:95]
  v_mfma_f32_16x16x32_bf16 v[28:31], v[148:151], a[220:223], v[28:31]
  ds_write_b128 v122, v[56:59] offset:7168
  v_mfma_f32_16x16x32_bf16 v[44:47], v[152:155], a[220:223], v[44:47]
  v_mfma_f32_16x16x32_bf16 v[60:63], v[156:159], a[220:223], v[60:63]
  ds_write_b128 v122, v[72:75] offset:8192
  v_mfma_f32_16x16x32_bf16 v[76:79], v[160:163], a[220:223], v[76:79]
  v_mfma_f32_16x16x32_bf16 v[92:95], v[164:167], a[220:223], v[92:95]
  ds_write_b128 v122, v[88:91] offset:9216
  v_mfma_f32_16x16x32_bf16 v[16:19], v[128:131], a[192:195], v[16:19]
  v_mfma_f32_16x16x32_bf16 v[32:35], v[132:135], a[192:195], v[32:35]
  ds_write_b128 v123, v[28:31] offset:10240
  v_mfma_f32_16x16x32_bf16 v[48:51], v[136:139], a[192:195], v[48:51]
  v_mfma_f32_16x16x32_bf16 v[64:67], v[140:143], a[192:195], v[64:67]
  ds_write_b128 v123, v[44:47] offset:11264
  v_mfma_f32_16x16x32_bf16 v[80:83], v[144:147], a[192:195], v[80:83]
  v_mfma_f32_16x16x32_bf16 v[16:19], v[148:151], a[208:211], v[16:19]
  ds_write_b128 v123, v[60:63] offset:12288
  v_mfma_f32_16x16x32_bf16 v[32:35], v[152:155], a[208:211], v[32:35]
  v_mfma_f32_16x16x32_bf16 v[48:51], v[156:159], a[208:211], v[48:51]
  ds_write_b128 v123, v[76:79] offset:13312
  v_mfma_f32_16x16x32_bf16 v[64:67], v[160:163], a[208:211], v[64:67]
  v_mfma_f32_16x16x32_bf16 v[80:83], v[164:167], a[208:211], v[80:83]
  ds_write_b128 v123, v[92:95] offset:14336
  s_waitcnt lgkmcnt(0)
  s_barrier
  ds_read_b128 v[128:131], v120 offset:0
  ds_read_b128 v[148:151], v120 offset:5120
  ds_read_b128 v[168:171], v120 offset:10240
  ds_read_b128 v[132:135], v120 offset:1024
  ds_read_b128 v[152:155], v120 offset:6144
  ds_read_b128 v[172:175], v120 offset:11264
  ds_read_b128 v[136:139], v120 offset:2048
  ds_read_b128 v[156:159], v120 offset:7168
  ds_read_b128 v[176:179], v120 offset:12288
  ds_read_b128 v[140:143], v120 offset:3072
  ds_read_b128 v[160:163], v120 offset:8192
  ds_read_b128 v[180:183], v120 offset:13312
  ds_read_b128 v[144:147], v120 offset:4096
  ds_read_b128 v[164:167], v120 offset:9216
  ds_read_b128 v[184:187], v120 offset:14336
  s_waitcnt lgkmcnt(14)
  v_pk_add_f32 v[16:17], v[16:17], v[128:129]
  v_pk_add_f32 v[18:19], v[18:19], v[130:131]
  s_waitcnt lgkmcnt(13)
  v_pk_add_f32 v[16:17], v[16:17], v[148:149]
  v_pk_add_f32 v[18:19], v[18:19], v[150:151]
  s_waitcnt lgkmcnt(12)
  v_pk_add_f32 v[16:17], v[16:17], v[168:169]
  v_pk_add_f32 v[18:19], v[18:19], v[170:171]
  v_cvt_pk_bf16_f32 v192, v16, v17
  v_cvt_pk_bf16_f32 v193, v18, v19
  s_waitcnt lgkmcnt(11)
  v_pk_add_f32 v[32:33], v[32:33], v[132:133]
  v_pk_add_f32 v[34:35], v[34:35], v[134:135]
  s_waitcnt lgkmcnt(10)
  v_pk_add_f32 v[32:33], v[32:33], v[152:153]
  v_pk_add_f32 v[34:35], v[34:35], v[154:155]
  s_waitcnt lgkmcnt(9)
  v_pk_add_f32 v[32:33], v[32:33], v[172:173]
  v_pk_add_f32 v[34:35], v[34:35], v[174:175]
  v_cvt_pk_bf16_f32 v194, v32, v33
  v_cvt_pk_bf16_f32 v195, v34, v35
L_stub11:
  s_cbranch_execz L_scret
  s_waitcnt lgkmcnt(8)
  v_pk_add_f32 v[48:49], v[48:49], v[136:137]
  v_pk_add_f32 v[50:51], v[50:51], v[138:139]
  s_waitcnt lgkmcnt(7)
  v_pk_add_f32 v[48:49], v[48:49], v[156:157]
  v_pk_add_f32 v[50:51], v[50:51], v[158:159]
  s_waitcnt lgkmcnt(6)
  v_pk_add_f32 v[48:49], v[48:49], v[176:177]
  v_pk_add_f32 v[50:51], v[50:51], v[178:179]
  v_cvt_pk_bf16_f32 v196, v48, v49
  v_cvt_pk_bf16_f32 v197, v50, v51
  v_permlane16_swap_b32 v192, v194
  v_permlane16_swap_b32 v193, v195
  buffer_store_dwordx4 v[192:195], v3, s[56:59], s34 offen offset:0 sc1
  s_waitcnt lgkmcnt(5)
  v_pk_add_f32 v[64:65], v[64:65], v[140:141]
  v_pk_add_f32 v[66:67], v[66:67], v[142:143]
  s_waitcnt lgkmcnt(4)
  v_pk_add_f32 v[64:65], v[64:65], v[160:161]
  v_pk_add_f32 v[66:67], v[66:67], v[162:163]
  s_waitcnt lgkmcnt(3)
  v_pk_add_f32 v[64:65], v[64:65], v[180:181]
  v_pk_add_f32 v[66:67], v[66:67], v[182:183]
  v_cvt_pk_bf16_f32 v198, v64, v65
  v_cvt_pk_bf16_f32 v199, v66, v67
  s_waitcnt lgkmcnt(2)
  v_pk_add_f32 v[80:81], v[80:81], v[144:145]
  v_pk_add_f32 v[82:83], v[82:83], v[146:147]
  s_waitcnt lgkmcnt(1)
  v_pk_add_f32 v[80:81], v[80:81], v[164:165]
  v_pk_add_f32 v[82:83], v[82:83], v[166:167]
  s_waitcnt lgkmcnt(0)
  v_pk_add_f32 v[80:81], v[80:81], v[184:185]
  v_pk_add_f32 v[82:83], v[82:83], v[186:187]
  v_cvt_pk_bf16_f32 v200, v80, v81
  v_cvt_pk_bf16_f32 v201, v82, v83
  v_permlane16_swap_b32 v196, v198
  v_permlane16_swap_b32 v197, v199
  buffer_store_dwordx4 v[196:199], v3, s[56:59], s34 offen offset:1024 sc1
  buffer_store_dwordx2 v[200:201], v4, s[56:59], s34 offen offset:2048 sc1
  buffer_load_dword v124, v98, s[64:67], 0 offen sc1
  s_branch L_page1
.p2align 12
L_page1:
L_stub12:
  s_cbranch_execz L_scret
  s_waitcnt vmcnt(0)
  s_barrier
  s_cmp_lg_u32 s3, 0
  s_cbranch_scc1 L_noflagC
  v_mov_b32 v106, s78
  v_mov_b32 v107, s4
  s_mov_b64 exec, 1
  buffer_store_dword v107, v106, s[64:67], 0 offen sc1
  s_mov_b64 exec, -1
L_noflagC:
  v_cmp_ne_u32 vcc, s4, v124
  s_cmp_eq_u64 vcc, 0
  s_cbranch_scc1 L_loadx
  s_branch L_phaseD
L_stub13:
  s_cbranch_execz L_scret
L_roleB:
  s_mov_b32 s7, s5
  s_sub_u32 s8, s6, 27
  v_mul_u32_u24 v20, 1280, v1
  v_lshlrev_b32 v21, 2, v1
  v_xor_b32 v21, v21, v2
  v_lshl_add_u32 v4, v21, 4, v20
  v_add_u32 v5, 4096, v4
  v_add_u32 v6, 8192, v4
  v_add_u32 v7, 12288, v4
  v_lshrrev_b32 v20, 3, v0
  v_mul_u32_u24 v20, 1280, v20
  v_and_b32 v21, 7, v0
  v_xor_b32 v21, v21, v1
  v_xor_b32 v22, 4, v21
  v_lshl_add_u32 v8, v21, 4, v20
  v_lshl_add_u32 v9, v22, 4, v20
  v_add_u32 v9, 9216, v9
  v_lshl_add_u32 v10, v21, 4, v20
  v_add_u32 v10, 18432, v10
  v_lshl_add_u32 v11, v22, 4, v20
  v_add_u32 v11, 27648, v11
  s_mul_i32 s11, s3, 20480
  s_lshl_b32 s10, s8, 8
  s_add_u32 s11, s11, s10
  s_lshl_b32 s12, s7, 2
  s_add_u32 s12, s12, s3
  s_mul_i32 s12, s12, 81920
  s_lshl_b32 s14, s3, 12
  s_lshl_b32 s15, s3, 13
  s_add_u32 s15, s15, 16384
  s_waitcnt lgkmcnt(0)
  s_mov_b32 s36, s16
  s_and_b32 s37, s17, 0xffff
  s_mov_b32 s38, 0x280000
  s_mov_b32 s39, 0x20000
  s_mov_b32 s48, s24
  s_and_b32 s49, s25, 0xffff
  s_mov_b32 s50, 0xc8000
  s_mov_b32 s51, 0x20000
  s_add_u32 m0, s14, 0
  s_add_u32 s13, s12, 40960
  buffer_load_dwordx4 v4, s[48:51], s11 offen offset:0  lds
  s_add_u32 s76, s32, 0x770000
  s_addc_u32 s77, s33, 0
  s_load_dword s4, s[76:77], 0
  s_add_u32 s64, s32, 0x700000
  s_addc_u32 s65, s33, 0
  s_and_b32 s65, s65, 0xffff
  buffer_load_dwordx4 v5, s[48:51], s11 offen offset:1024  lds
  s_mov_b32 s66, 0x80000
  s_mov_b32 s67, 0x20000
  v_bfe_u32 v20, v0, 2, 2
  v_and_b32 v21, 3, v0
  buffer_load_dwordx4 v6, s[48:51], s11 offen offset:2048  lds
  v_lshrrev_b32 v23, 5, v0
  v_lshlrev_b32 v22, 11, v23
  v_lshl_add_u32 v22, v20, 8, v22
  v_lshl_add_u32 v22, v21, 3, v22
  buffer_load_dwordx4 v7, s[48:51], s11 offen offset:3072  lds
  v_and_b32 v21, 1, v1
  v_lshlrev_b32 v20, 1, v20
  v_xor_b32 v20, v20, v21
  s_and_b32 s10, s3, 1
  s_add_u32 m0, s15, 0
  s_add_u32 s11, s11, 81920
  buffer_load_dwordx4 v8, s[36:39], s12 offen offset:0  lds
  s_lshl_b32 s10, s10, 2
  v_xor_b32 v20, s10, v20
  v_lshl_add_u32 v12, v20, 5, v22
  v_xor_b32 v13, 64, v12
  buffer_load_dwordx4 v9, s[36:39], s12 offen offset:1024  lds
  s_lshr_b32 s10, s3, 1
  s_lshl_b32 s10, s10, 14
  s_add_u32 s10, s10, 16384
  v_and_b32 v22, 31, v0
  buffer_load_dwordx4 v10, s[36:39], s12 offen offset:2048  lds
  v_lshlrev_b32 v22, 7, v22
  v_add_u32 v22, s10, v22
  v_bfe_u32 v20, v0, 1, 3
  v_xor_b32 v20, v20, v23
  buffer_load_dwordx4 v11, s[36:39], s12 offen offset:3072  lds
  v_lshl_add_u32 v14, v20, 4, v22
  v_xor_b32 v15, 32, v14
  v_xor_b32 v16, 64, v14
  v_xor_b32 v17, 96, v14
  s_add_u32 m0, s15, 4096
  s_add_u32 s12, s12, 128
  buffer_load_dwordx4 v8, s[36:39], s13 offen offset:0  lds
  s_add_u32 s40, s32, 0x480000
  s_addc_u32 s41, s33, 0
  s_and_b32 s41, s41, 0xffff
  s_mov_b32 s42, 0x280000
  s_mov_b32 s43, 0x20000
  buffer_load_dwordx4 v9, s[36:39], s13 offen offset:1024  lds
  s_lshl_b32 s74, s7, 1
  s_lshr_b32 s9, s3, 1
  s_add_u32 s74, s74, s9
  s_mul_i32 s74, s74, 163840
  buffer_load_dwordx4 v10, s[36:39], s13 offen offset:2048  lds
  s_lshl_b32 s9, s8, 12
  s_add_u32 s74, s74, s9
  s_and_b32 s9, s3, 1
  s_lshl_b32 s9, s9, 11
  buffer_load_dwordx4 v11, s[36:39], s13 offen offset:3072  lds
  s_add_u32 s74, s74, s9
  v_and_b32 v20, 1, v1
  v_mul_u32_u24 v20, 20480, v20
  v_lshl_add_u32 v20, v23, 8, v20
  s_add_u32 m0, s14, 49152
  s_add_u32 s13, s12, 40960
  buffer_load_dwordx4 v4, s[48:51], s11 offen offset:0  lds
  v_lshl_add_u32 v18, v2, 4, v20
  s_add_u32 s78, s7, 40
  s_lshl_b32 s78, s78, 8
  s_lshl_b32 s9, s8, 2
  buffer_load_dwordx4 v5, s[48:51], s11 offen offset:1024  lds
  s_add_u32 s78, s78, s9
  s_mov_b32 s34, 0
  s_mov_b32 s72, 98304
  s_mov_b32 s73, 0
  buffer_load_dwordx4 v6, s[48:51], s11 offen offset:2048  lds
  s_mov_b32 s35, 49152
  buffer_load_dwordx4 v7, s[48:51], s11 offen offset:3072  lds
  s_add_u32 m0, s15, 49152
  s_add_u32 s11, s11, 81920
  buffer_load_dwordx4 v8, s[36:39], s12 offen offset:0  lds
  buffer_load_dwordx4 v9, s[36:39], s12 offen offset:1024  lds
  s_waitcnt lgkmcnt(0)
  s_add_u32 s4, s4, 1
  s_or_b32 s4, s4, 0x80000000
  s_waitcnt vmcnt(6)
  s_barrier
  ds_read_b64_tr_b16 a[0:1], v12 offset:0
  ds_read_b64_tr_b16 a[2:3], v12 offset:1024
  ds_read_b64_tr_b16 a[4:5], v13 offset:0
  ds_read_b64_tr_b16 a[6:7], v13 offset:1024
  ds_read_b128 a[8:11], v14 offset:0
  ds_read_b128 a[12:15], v14 offset:4096
  ds_read_b128 a[16:19], v14 offset:8192
  ds_read_b128 a[20:23], v14 offset:12288
  ds_read_b64_tr_b16 a[24:25], v12 offset:4096
  ds_read_b64_tr_b16 a[26:27], v12 offset:5120
L_stub14:
  s_cbranch_execz L_scret
  ds_read_b64_tr_b16 a[28:29], v13 offset:4096
  ds_read_b64_tr_b16 a[30:31], v13 offset:5120
  ds_read_b128 a[32:35], v15 offset:0
  ds_read_b128 a[36:39], v15 offset:4096
  ds_read_b128 a[40:43], v15 offset:8192
  ds_read_b128 a[44:47], v15 offset:12288
  s_waitcnt lgkmcnt(0)
  v_mfma_f32_32x32x16_bf16 v[128:143], a[0:3], a[8:11], 0
  buffer_load_dwordx4 v10, s[36:39], s12 offen offset:2048  lds
  ds_read_b64_tr_b16 a[48:49], v12 offset:8192
  v_mfma_f32_32x32x16_bf16 v[144:159], a[4:7], a[8:11], 0
  buffer_load_dwordx4 v11, s[36:39], s12 offen offset:3072  lds
  ds_read_b64_tr_b16 a[50:51], v12 offset:9216
  v_mfma_f32_32x32x16_bf16 v[160:175], a[0:3], a[12:15], 0
  s_add_u32 m0, s15, 53248
  s_add_u32 s12, s12, 128
  buffer_load_dwordx4 v8, s[36:39], s13 offen offset:0  lds
  ds_read_b64_tr_b16 a[52:53], v13 offset:8192
  v_mfma_f32_32x32x16_bf16 v[176:191], a[4:7], a[12:15], 0
  buffer_load_dwordx4 v9, s[36:39], s13 offen offset:1024  lds
  ds_read_b64_tr_b16 a[54:55], v13 offset:9216
  v_mfma_f32_32x32x16_bf16 v[192:207], a[0:3], a[16:19], 0
  buffer_load_dwordx4 v10, s[36:39], s13 offen offset:2048  lds
  ds_read_b128 a[56:59], v16 offset:0
  v_mfma_f32_32x32x16_bf16 v[208:223], a[4:7], a[16:19], 0
  buffer_load_dwordx4 v11, s[36:39], s13 offen offset:3072  lds
  ds_read_b128 a[60:63], v16 offset:4096
  v_mfma_f32_32x32x16_bf16 v[224:239], a[0:3], a[20:23], 0
  ds_read_b128 a[64:67], v16 offset:8192
  ds_read_b128 a[68:71], v16 offset:12288
  v_mfma_f32_32x32x16_bf16 v[240:255], a[4:7], a[20:23], 0
  s_add_u32 m0, s14, s72
  s_add_u32 s13, s12, 40960
  buffer_load_dwordx4 v4, s[48:51], s11 offen offset:0  lds
  ds_read_b64_tr_b16 a[72:73], v12 offset:12288
  v_mfma_f32_32x32x16_bf16 v[128:143], a[24:27], a[32:35], v[128:143]
  ds_read_b64_tr_b16 a[74:75], v12 offset:13312
  ds_read_b64_tr_b16 a[76:77], v13 offset:12288
  v_mfma_f32_32x32x16_bf16 v[144:159], a[28:31], a[32:35], v[144:159]
  buffer_load_dwordx4 v5, s[48:51], s11 offen offset:1024  lds
  ds_read_b64_tr_b16 a[78:79], v13 offset:13312
  v_mfma_f32_32x32x16_bf16 v[160:175], a[24:27], a[36:39], v[160:175]
  ds_read_b128 a[80:83], v17 offset:0
  ds_read_b128 a[84:87], v17 offset:4096
  v_mfma_f32_32x32x16_bf16 v[176:191], a[28:31], a[36:39], v[176:191]
  buffer_load_dwordx4 v6, s[48:51], s11 offen offset:2048  lds
  ds_read_b128 a[88:91], v17 offset:8192
  v_mfma_f32_32x32x16_bf16 v[192:207], a[24:27], a[40:43], v[192:207]
  buffer_load_dwordx4 v7, s[48:51], s11 offen offset:3072  lds
  ds_read_b128 a[92:95], v17 offset:12288
  v_mfma_f32_32x32x16_bf16 v[208:223], a[28:31], a[40:43], v[208:223]
  s_add_u32 m0, s15, s72
  s_add_u32 s11, s11, 81920
  buffer_load_dwordx4 v8, s[36:39], s12 offen offset:0  lds
  v_mfma_f32_32x32x16_bf16 v[224:239], a[24:27], a[44:47], v[224:239]
  v_add_u32 v12, s35, v12
  v_add_u32 v13, s35, v13
  v_add_u32 v14, s35, v14
  v_mfma_f32_32x32x16_bf16 v[240:255], a[28:31], a[44:47], v[240:255]
  buffer_load_dwordx4 v9, s[36:39], s12 offen offset:1024  lds
  v_add_u32 v15, s35, v15
  v_add_u32 v16, s35, v16
  v_add_u32 v17, s35, v17
  s_branch L_bmid
.p2align 6
L_bloop:
  v_mfma_f32_32x32x16_bf16 v[128:143], a[0:3], a[8:11], v[128:143]
  ds_read_b64_tr_b16 a[48:49], v12 offset:8192
  ds_read_b64_tr_b16 a[50:51], v12 offset:9216
  v_mfma_f32_32x32x16_bf16 v[144:159], a[4:7], a[8:11], v[144:159]
  ds_read_b64_tr_b16 a[52:53], v13 offset:8192
  ds_read_b64_tr_b16 a[54:55], v13 offset:9216
  v_mfma_f32_32x32x16_bf16 v[160:175], a[0:3], a[12:15], v[160:175]
  s_add_u32 m0, s14, s72
  s_add_u32 s13, s12, 40960
  buffer_load_dwordx4 v4, s[48:51], s11 offen offset:0  lds
  v_mfma_f32_32x32x16_bf16 v[176:191], a[4:7], a[12:15], v[176:191]
  ds_read_b128 a[56:59], v16 offset:0
  ds_read_b128 a[60:63], v16 offset:4096
  v_mfma_f32_32x32x16_bf16 v[192:207], a[0:3], a[16:19], v[192:207]
  ds_read_b128 a[64:67], v16 offset:8192
  ds_read_b128 a[68:71], v16 offset:12288
  v_mfma_f32_32x32x16_bf16 v[208:223], a[4:7], a[16:19], v[208:223]
  buffer_load_dwordx4 v5, s[48:51], s11 offen offset:1024  lds
  v_mfma_f32_32x32x16_bf16 v[224:239], a[0:3], a[20:23], v[224:239]
  ds_read_b64_tr_b16 a[72:73], v12 offset:12288
  ds_read_b64_tr_b16 a[74:75], v12 offset:13312
  v_mfma_f32_32x32x16_bf16 v[240:255], a[4:7], a[20:23], v[240:255]
  ds_read_b64_tr_b16 a[76:77], v13 offset:12288
  ds_read_b64_tr_b16 a[78:79], v13 offset:13312
  v_mfma_f32_32x32x16_bf16 v[128:143], a[24:27], a[32:35], v[128:143]
  buffer_load_dwordx4 v6, s[48:51], s11 offen offset:2048  lds
  v_mfma_f32_32x32x16_bf16 v[144:159], a[28:31], a[32:35], v[144:159]
  ds_read_b128 a[80:83], v17 offset:0
  ds_read_b128 a[84:87], v17 offset:4096
  v_mfma_f32_32x32x16_bf16 v[160:175], a[24:27], a[36:39], v[160:175]
  ds_read_b128 a[88:91], v17 offset:8192
  ds_read_b128 a[92:95], v17 offset:12288
  v_mfma_f32_32x32x16_bf16 v[176:191], a[28:31], a[36:39], v[176:191]
  buffer_load_dwordx4 v7, s[48:51], s11 offen offset:3072  lds
  v_mfma_f32_32x32x16_bf16 v[192:207], a[24:27], a[40:43], v[192:207]
  v_add_u32 v12, s35, v12
  v_add_u32 v13, s35, v13
  v_add_u32 v14, s35, v14
  v_mfma_f32_32x32x16_bf16 v[208:223], a[28:31], a[40:43], v[208:223]
  s_add_u32 m0, s15, s72
  s_add_u32 s11, s11, 81920
  buffer_load_dwordx4 v8, s[36:39], s12 offen offset:0  lds
  v_mfma_f32_32x32x16_bf16 v[224:239], a[24:27], a[44:47], v[224:239]
  v_add_u32 v15, s35, v15
  v_add_u32 v16, s35, v16
  v_add_u32 v17, s35, v17
  v_mfma_f32_32x32x16_bf16 v[240:255], a[28:31], a[44:47], v[240:255]
  buffer_load_dwordx4 v9, s[36:39], s12 offen offset:1024  lds
L_bmid:
  s_waitcnt vmcnt(6) lgkmcnt(0)
  s_barrier
  v_mfma_f32_32x32x16_bf16 v[128:143], a[48:51], a[56:59], v[128:143]
  ds_read_b64_tr_b16 a[0:1], v12 offset:0
  ds_read_b64_tr_b16 a[2:3], v12 offset:1024
  v_mfma_f32_32x32x16_bf16 v[144:159], a[52:55], a[56:59], v[144:159]
  ds_read_b64_tr_b16 a[4:5], v13 offset:0
  ds_read_b64_tr_b16 a[6:7], v13 offset:1024
  v_mfma_f32_32x32x16_bf16 v[160:175], a[48:51], a[60:63], v[160:175]
  buffer_load_dwordx4 v10, s[36:39], s12 offen offset:2048  lds
  v_mfma_f32_32x32x16_bf16 v[176:191], a[52:55], a[60:63], v[176:191]
L_stub15:
  s_cbranch_execz L_scret
  ds_read_b128 a[8:11], v14 offset:0
  ds_read_b128 a[12:15], v14 offset:4096
  v_mfma_f32_32x32x16_bf16 v[192:207], a[48:51], a[64:67], v[192:207]
  ds_read_b128 a[16:19], v14 offset:8192
  ds_read_b128 a[20:23], v14 offset:12288
  v_mfma_f32_32x32x16_bf16 v[208:223], a[52:55], a[64:67], v[208:223]
  buffer_load_dwordx4 v11, s[36:39], s12 offen offset:3072  lds
  v_mfma_f32_32x32x16_bf16 v[224:239], a[48:51], a[68:71], v[224:239]
  ds_read_b64_tr_b16 a[24:25], v12 offset:4096
  ds_read_b64_tr_b16 a[26:27], v12 offset:5120
  v_mfma_f32_32x32x16_bf16 v[240:255], a[52:55], a[68:71], v[240:255]
  ds_read_b64_tr_b16 a[28:29], v13 offset:4096
  ds_read_b64_tr_b16 a[30:31], v13 offset:5120
  v_mfma_f32_32x32x16_bf16 v[128:143], a[72:75], a[80:83], v[128:143]
  s_add_u32 m0, m0, 4096
  s_add_u32 s12, s12, 128
  buffer_load_dwordx4 v8, s[36:39], s13 offen offset:0  lds
  v_mfma_f32_32x32x16_bf16 v[144:159], a[76:79], a[80:83], v[144:159]
  ds_read_b128 a[32:35], v15 offset:0
  ds_read_b128 a[36:39], v15 offset:4096
  v_mfma_f32_32x32x16_bf16 v[160:175], a[72:75], a[84:87], v[160:175]
  ds_read_b128 a[40:43], v15 offset:8192
  ds_read_b128 a[44:47], v15 offset:12288
  v_mfma_f32_32x32x16_bf16 v[176:191], a[76:79], a[84:87], v[176:191]
  buffer_load_dwordx4 v9, s[36:39], s13 offen offset:1024  lds
  v_mfma_f32_32x32x16_bf16 v[192:207], a[72:75], a[88:91], v[192:207]
  s_add_u32 s34, s34, 1
  s_mov_b32 s9, s73
  s_add_u32 s73, s73, s35
  v_mfma_f32_32x32x16_bf16 v[208:223], a[76:79], a[88:91], v[208:223]
  buffer_load_dwordx4 v10, s[36:39], s13 offen offset:2048  lds
  v_mfma_f32_32x32x16_bf16 v[224:239], a[72:75], a[92:95], v[224:239]
  s_mov_b32 s35, 49152
  s_cmp_eq_u32 s73, 98304
  s_cselect_b32 s35, 0xfffe8000, s35
  v_mfma_f32_32x32x16_bf16 v[240:255], a[76:79], a[92:95], v[240:255]
  buffer_load_dwordx4 v11, s[36:39], s13 offen offset:3072  lds
  s_mov_b32 s72, s9
  s_cmp_lt_u32 s34, 8
  s_waitcnt lgkmcnt(0)
  s_cbranch_scc1 L_bloop
  v_mfma_f32_32x32x16_bf16 v[128:143], a[0:3], a[8:11], v[128:143]
  ds_read_b64_tr_b16 a[48:49], v12 offset:8192
  ds_read_b64_tr_b16 a[50:51], v12 offset:9216
  v_mfma_f32_32x32x16_bf16 v[144:159], a[4:7], a[8:11], v[144:159]
  ds_read_b64_tr_b16 a[52:53], v13 offset:8192
  ds_read_b64_tr_b16 a[54:55], v13 offset:9216
  v_mfma_f32_32x32x16_bf16 v[160:175], a[0:3], a[12:15], v[160:175]
  ds_read_b128 a[56:59], v16 offset:0
  ds_read_b128 a[60:63], v16 offset:4096
  v_mfma_f32_32x32x16_bf16 v[176:191], a[4:7], a[12:15], v[176:191]
  ds_read_b128 a[64:67], v16 offset:8192
  ds_read_b128 a[68:71], v16 offset:12288
  v_mfma_f32_32x32x16_bf16 v[192:207], a[0:3], a[16:19], v[192:207]
  ds_read_b64_tr_b16 a[72:73], v12 offset:12288
  ds_read_b64_tr_b16 a[74:75], v12 offset:13312
  v_mfma_f32_32x32x16_bf16 v[208:223], a[4:7], a[16:19], v[208:223]
  ds_read_b64_tr_b16 a[76:77], v13 offset:12288
  ds_read_b64_tr_b16 a[78:79], v13 offset:13312
  v_mfma_f32_32x32x16_bf16 v[224:239], a[0:3], a[20:23], v[224:239]
  ds_read_b128 a[80:83], v17 offset:0
  ds_read_b128 a[84:87], v17 offset:4096
  v_mfma_f32_32x32x16_bf16 v[240:255], a[4:7], a[20:23], v[240:255]
  ds_read_b128 a[88:91], v17 offset:8192
  ds_read_b128 a[92:95], v17 offset:12288
  v_mfma_f32_32x32x16_bf16 v[128:143], a[24:27], a[32:35], v[128:143]
  v_add_u32 v12, s35, v12
  v_add_u32 v13, s35, v13
  v_add_u32 v14, s35, v14
  v_mfma_f32_32x32x16_bf16 v[144:159], a[28:31], a[32:35], v[144:159]
  v_add_u32 v15, s35, v15
  v_add_u32 v16, s35, v16
  v_add_u32 v17, s35, v17
  v_mfma_f32_32x32x16_bf16 v[160:175], a[24:27], a[36:39], v[160:175]
  v_mfma_f32_32x32x16_bf16 v[176:191], a[28:31], a[36:39], v[176:191]
  v_mfma_f32_32x32x16_bf16 v[192:207], a[24:27], a[40:43], v[192:207]
  v_mfma_f32_32x32x16_bf16 v[208:223], a[28:31], a[40:43], v[208:223]
  v_mfma_f32_32x32x16_bf16 v[224:239], a[24:27], a[44:47], v[224:239]
  v_mfma_f32_32x32x16_bf16 v[240:255], a[28:31], a[44:47], v[240:255]
  s_waitcnt vmcnt(0) lgkmcnt(0)
  s_barrier
  v_mfma_f32_32x32x16_bf16 v[128:143], a[48:51], a[56:59], v[128:143]
  ds_read_b64_tr_b16 a[0:1], v12 offset:0
  ds_read_b64_tr_b16 a[2:3], v12 offset:1024
  v_mfma_f32_32x32x16_bf16 v[144:159], a[52:55], a[56:59], v[144:159]
  ds_read_b64_tr_b16 a[4:5], v13 offset:0
  ds_read_b64_tr_b16 a[6:7], v13 offset:1024
  v_mfma_f32_32x32x16_bf16 v[160:175], a[48:51], a[60:63], v[160:175]
  ds_read_b128 a[8:11], v14 offset:0
  ds_read_b128 a[12:15], v14 offset:4096
  v_mfma_f32_32x32x16_bf16 v[176:191], a[52:55], a[60:63], v[176:191]
  ds_read_b128 a[16:19], v14 offset:8192
  ds_read_b128 a[20:23], v14 offset:12288
  v_mfma_f32_32x32x16_bf16 v[192:207], a[48:51], a[64:67], v[192:207]
  ds_read_b64_tr_b16 a[24:25], v12 offset:4096
  ds_read_b64_tr_b16 a[26:27], v12 offset:5120
  v_mfma_f32_32x32x16_bf16 v[208:223], a[52:55], a[64:67], v[208:223]
  ds_read_b64_tr_b16 a[28:29], v13 offset:4096
  ds_read_b64_tr_b16 a[30:31], v13 offset:5120
  v_mfma_f32_32x32x16_bf16 v[224:239], a[48:51], a[68:71], v[224:239]
  ds_read_b128 a[32:35], v15 offset:0
  ds_read_b128 a[36:39], v15 offset:4096
  v_mfma_f32_32x32x16_bf16 v[240:255], a[52:55], a[68:71], v[240:255]
  ds_read_b128 a[40:43], v15 offset:8192
  ds_read_b128 a[44:47], v15 offset:12288
  v_mfma_f32_32x32x16_bf16 v[128:143], a[72:75], a[80:83], v[128:143]
  v_mfma_f32_32x32x16_bf16 v[144:159], a[76:79], a[80:83], v[144:159]
  v_mfma_f32_32x32x16_bf16 v[160:175], a[72:75], a[84:87], v[160:175]
  v_mfma_f32_32x32x16_bf16 v[176:191], a[76:79], a[84:87], v[176:191]
  v_mfma_f32_32x32x16_bf16 v[192:207], a[72:75], a[88:91], v[192:207]
  v_mfma_f32_32x32x16_bf16 v[208:223], a[76:79], a[88:91], v[208:223]
  v_mfma_f32_32x32x16_bf16 v[224:239], a[72:75], a[92:95], v[224:239]
  v_mfma_f32_32x32x16_bf16 v[240:255], a[76:79], a[92:95], v[240:255]
  s_waitcnt lgkmcnt(0)
  v_mfma_f32_32x32x16_bf16 v[128:143], a[0:3], a[8:11], v[128:143]
  ds_read_b64_tr_b16 a[48:49], v12 offset:8192
  ds_read_b64_tr_b16 a[50:51], v12 offset:9216
  v_mfma_f32_32x32x16_bf16 v[144:159], a[4:7], a[8:11], v[144:159]
  ds_read_b64_tr_b16 a[52:53], v13 offset:8192
  ds_read_b64_tr_b16 a[54:55], v13 offset:9216
  v_mfma_f32_32x32x16_bf16 v[128:143], a[24:27], a[32:35], v[128:143]
L_stub16:
  s_cbranch_execz L_scret
  ds_read_b64_tr_b16 a[72:73], v12 offset:12288
  ds_read_b64_tr_b16 a[74:75], v12 offset:13312
  v_mfma_f32_32x32x16_bf16 v[144:159], a[28:31], a[32:35], v[144:159]
  ds_read_b64_tr_b16 a[76:77], v13 offset:12288
  ds_read_b64_tr_b16 a[78:79], v13 offset:13312
  v_mfma_f32_32x32x16_bf16 v[160:175], a[0:3], a[12:15], v[160:175]
  ds_read_b128 a[56:59], v16 offset:0
  ds_read_b128 a[80:83], v17 offset:0
  v_mfma_f32_32x32x16_bf16 v[176:191], a[4:7], a[12:15], v[176:191]
  ds_read_b128 a[60:63], v16 offset:4096
  ds_read_b128 a[84:87], v17 offset:4096
  v_mfma_f32_32x32x16_bf16 v[160:175], a[24:27], a[36:39], v[160:175]
  ds_read_b128 a[64:67], v16 offset:8192
  ds_read_b128 a[88:91], v17 offset:8192
  v_mfma_f32_32x32x16_bf16 v[176:191], a[28:31], a[36:39], v[176:191]
  ds_read_b128 a[68:71], v16 offset:12288
  ds_read_b128 a[92:95], v17 offset:12288
  s_waitcnt lgkmcnt(6)
  v_mfma_f32_32x32x16_bf16 v[128:143], a[48:51], a[56:59], v[128:143]
  v_mfma_f32_32x32x16_bf16 v[144:159], a[52:55], a[56:59], v[144:159]
  v_mfma_f32_32x32x16_bf16 v[128:143], a[72:75], a[80:83], v[128:143]
  v_mfma_f32_32x32x16_bf16 v[144:159], a[76:79], a[80:83], v[144:159]
  s_waitcnt lgkmcnt(4)
  v_mfma_f32_32x32x16_bf16 v[160:175], a[48:51], a[60:63], v[160:175]
  v_mfma_f32_32x32x16_bf16 v[176:191], a[52:55], a[60:63], v[176:191]
  v_mfma_f32_32x32x16_bf16 v[160:175], a[72:75], a[84:87], v[160:175]
  v_mfma_f32_32x32x16_bf16 v[176:191], a[76:79], a[84:87], v[176:191]
  v_mfma_f32_32x32x16_bf16 v[192:207], a[0:3], a[16:19], v[192:207]
  v_mfma_f32_32x32x16_bf16 v[208:223], a[4:7], a[16:19], v[208:223]
  v_mfma_f32_32x32x16_bf16 v[192:207], a[24:27], a[40:43], v[192:207]
  v_mfma_f32_32x32x16_bf16 v[208:223], a[28:31], a[40:43], v[208:223]
  s_waitcnt lgkmcnt(2)
  v_mfma_f32_32x32x16_bf16 v[192:207], a[48:51], a[64:67], v[192:207]
  v_mfma_f32_32x32x16_bf16 v[208:223], a[52:55], a[64:67], v[208:223]
  v_cvt_pk_bf16_f32 v32, v128, v129
  v_cvt_pk_bf16_f32 v33, v130, v131
  v_cvt_pk_bf16_f32 v34, v132, v133
  v_cvt_pk_bf16_f32 v35, v134, v135
  v_mfma_f32_32x32x16_bf16 v[192:207], a[72:75], a[88:91], v[192:207]
  v_cvt_pk_bf16_f32 v36, v136, v137
  v_cvt_pk_bf16_f32 v37, v138, v139
  v_cvt_pk_bf16_f32 v38, v140, v141
  v_cvt_pk_bf16_f32 v39, v142, v143
  v_mfma_f32_32x32x16_bf16 v[208:223], a[76:79], a[88:91], v[208:223]
  v_permlane32_swap_b32 v32, v34
  v_permlane32_swap_b32 v33, v35
  buffer_store_dwordx4 v[32:35], v18, s[40:43], s74 offen offset:0 sc1
  v_permlane32_swap_b32 v36, v38
  v_mfma_f32_32x32x16_bf16 v[224:239], a[0:3], a[20:23], v[224:239]
  v_permlane32_swap_b32 v37, v39
  buffer_store_dwordx4 v[36:39], v18, s[40:43], s74 offen offset:512 sc1
  v_cvt_pk_bf16_f32 v40, v144, v145
  v_cvt_pk_bf16_f32 v41, v146, v147
  v_mfma_f32_32x32x16_bf16 v[240:255], a[4:7], a[20:23], v[240:255]
  v_cvt_pk_bf16_f32 v42, v148, v149
  v_cvt_pk_bf16_f32 v43, v150, v151
  v_cvt_pk_bf16_f32 v44, v152, v153
  v_cvt_pk_bf16_f32 v45, v154, v155
  v_mfma_f32_32x32x16_bf16 v[224:239], a[24:27], a[44:47], v[224:239]
  v_cvt_pk_bf16_f32 v46, v156, v157
  v_cvt_pk_bf16_f32 v47, v158, v159
  v_permlane32_swap_b32 v40, v42
  v_permlane32_swap_b32 v41, v43
  v_mfma_f32_32x32x16_bf16 v[240:255], a[28:31], a[44:47], v[240:255]
  buffer_store_dwordx4 v[40:43], v18, s[40:43], s74 offen offset:1024 sc1
  v_permlane32_swap_b32 v44, v46
  v_permlane32_swap_b32 v45, v47
  buffer_store_dwordx4 v[44:47], v18, s[40:43], s74 offen offset:1536 sc1
  s_waitcnt lgkmcnt(0)
  v_mfma_f32_32x32x16_bf16 v[224:239], a[48:51], a[68:71], v[224:239]
  s_add_u32 s74, s74, 40960
  v_cvt_pk_bf16_f32 v48, v160, v161
  v_cvt_pk_bf16_f32 v49, v162, v163
  v_cvt_pk_bf16_f32 v50, v164, v165
  v_mfma_f32_32x32x16_bf16 v[240:255], a[52:55], a[68:71], v[240:255]
  v_cvt_pk_bf16_f32 v51, v166, v167
  v_cvt_pk_bf16_f32 v52, v168, v169
  v_cvt_pk_bf16_f32 v53, v170, v171
  v_cvt_pk_bf16_f32 v54, v172, v173
  v_mfma_f32_32x32x16_bf16 v[224:239], a[72:75], a[92:95], v[224:239]
  v_cvt_pk_bf16_f32 v55, v174, v175
  v_permlane32_swap_b32 v48, v50
  v_permlane32_swap_b32 v49, v51
  buffer_store_dwordx4 v[48:51], v18, s[40:43], s74 offen offset:0 sc1
  v_mfma_f32_32x32x16_bf16 v[240:255], a[76:79], a[92:95], v[240:255]
  v_permlane32_swap_b32 v52, v54
  v_permlane32_swap_b32 v53, v55
  buffer_store_dwordx4 v[52:55], v18, s[40:43], s74 offen offset:512 sc1
  v_cvt_pk_bf16_f32 v56, v176, v177
  v_cvt_pk_bf16_f32 v57, v178, v179
  v_cvt_pk_bf16_f32 v58, v180, v181
  v_cvt_pk_bf16_f32 v59, v182, v183
  v_cvt_pk_bf16_f32 v60, v184, v185
  v_cvt_pk_bf16_f32 v61, v186, v187
  v_cvt_pk_bf16_f32 v62, v188, v189
  v_cvt_pk_bf16_f32 v63, v190, v191
  v_permlane32_swap_b32 v56, v58
  v_permlane32_swap_b32 v57, v59
  buffer_store_dwordx4 v[56:59], v18, s[40:43], s74 offen offset:1024 sc1
  v_permlane32_swap_b32 v60, v62
  v_permlane32_swap_b32 v61, v63
  buffer_store_dwordx4 v[60:63], v18, s[40:43], s74 offen offset:1536 sc1
  s_add_u32 s74, s74, 40960
  v_cvt_pk_bf16_f32 v64, v192, v193
  v_cvt_pk_bf16_f32 v65, v194, v195
  v_cvt_pk_bf16_f32 v66, v196, v197
  v_cvt_pk_bf16_f32 v67, v198, v199
  v_cvt_pk_bf16_f32 v68, v200, v201
  v_cvt_pk_bf16_f32 v69, v202, v203
  v_cvt_pk_bf16_f32 v70, v204, v205
  v_cvt_pk_bf16_f32 v71, v206, v207
  v_permlane32_swap_b32 v64, v66
  v_permlane32_swap_b32 v65, v67
  buffer_store_dwordx4 v[64:67], v18, s[40:43], s74 offen offset:0 sc1
  v_permlane32_swap_b32 v68, v70
  v_permlane32_swap_b32 v69, v71
  buffer_store_dwordx4 v[68:71], v18, s[40:43], s74 offen offset:512 sc1
  v_cvt_pk_bf16_f32 v72, v208, v209
  v_cvt_pk_bf16_f32 v73, v210, v211
  v_cvt_pk_bf16_f32 v74, v212, v213
  v_cvt_pk_bf16_f32 v75, v214, v215
  v_cvt_pk_bf16_f32 v76, v216, v217
  v_cvt_pk_bf16_f32 v77, v218, v219
  v_cvt_pk_bf16_f32 v78, v220, v221
  v_cvt_pk_bf16_f32 v79, v222, v223
L_stub17:
  s_cbranch_execz L_scret
  v_permlane32_swap_b32 v72, v74
  v_permlane32_swap_b32 v73, v75
  buffer_store_dwordx4 v[72:75], v18, s[40:43], s74 offen offset:1024 sc1
  v_permlane32_swap_b32 v76, v78
  v_permlane32_swap_b32 v77, v79
  buffer_store_dwordx4 v[76:79], v18, s[40:43], s74 offen offset:1536 sc1
  s_add_u32 s74, s74, 40960
  v_cvt_pk_bf16_f32 v80, v224, v225
  v_cvt_pk_bf16_f32 v81, v226, v227
  v_cvt_pk_bf16_f32 v82, v228, v229
  v_cvt_pk_bf16_f32 v83, v230, v231
  v_cvt_pk_bf16_f32 v84, v232, v233
  v_cvt_pk_bf16_f32 v85, v234, v235
  v_cvt_pk_bf16_f32 v86, v236, v237
  v_cvt_pk_bf16_f32 v87, v238, v239
  v_permlane32_swap_b32 v80, v82
  v_permlane32_swap_b32 v81, v83
  buffer_store_dwordx4 v[80:83], v18, s[40:43], s74 offen offset:0 sc1
  v_permlane32_swap_b32 v84, v86
  v_permlane32_swap_b32 v85, v87
  buffer_store_dwordx4 v[84:87], v18, s[40:43], s74 offen offset:512 sc1
  v_cvt_pk_bf16_f32 v88, v240, v241
  v_cvt_pk_bf16_f32 v89, v242, v243
  v_cvt_pk_bf16_f32 v90, v244, v245
  v_cvt_pk_bf16_f32 v91, v246, v247
  v_cvt_pk_bf16_f32 v92, v248, v249
  v_cvt_pk_bf16_f32 v93, v250, v251
  v_cvt_pk_bf16_f32 v94, v252, v253
  v_cvt_pk_bf16_f32 v95, v254, v255
  v_permlane32_swap_b32 v88, v90
  v_permlane32_swap_b32 v89, v91
  buffer_store_dwordx4 v[88:91], v18, s[40:43], s74 offen offset:1024 sc1
  v_permlane32_swap_b32 v92, v94
  v_permlane32_swap_b32 v93, v95
  buffer_store_dwordx4 v[92:95], v18, s[40:43], s74 offen offset:1536 sc1
  s_add_u32 s44, s32, 0x240000
  s_addc_u32 s45, s33, 0
  s_and_b32 s45, s45, 0xffff
  s_mov_b32 s46, 0x221000
  s_mov_b32 s47, 0x20000
  s_mov_b32 s68, s28
  s_and_b32 s69, s29, 0xffff
  s_mov_b32 s70, 0x6c0000
  s_mov_b32 s71, 0x20000
  s_lshr_b32 s9, s5, 1
  s_and_b32 s10, s5, 1
  s_mul_i32 s75, s9, 4
  s_lshr_b32 s9, s6, 3
  s_add_u32 s75, s75, s9
  s_mul_i32 s76, s10, 8
  s_and_b32 s9, s6, 7
  s_add_u32 s76, s76, s9
  v_lshlrev_b32 v96, 4, v0
  v_add_u32 v97, 4096, v96
  v_add_u32 v104, 0x10000, v96
  v_add_u32 v105, 0x20000, v96
  s_add_u32 s9, s75, s76
  s_add_u32 s10, s9, 0
  s_and_b32 s10, s10, 3
  s_mul_i32 s16, s10, 5120
  s_add_u32 s10, s9, 1
  s_and_b32 s10, s10, 3
  s_mul_i32 s17, s10, 5120
  s_add_u32 s10, s9, 2
  s_and_b32 s10, s10, 3
  s_mul_i32 s18, s10, 5120
  s_add_u32 s10, s9, 3
  s_and_b32 s10, s10, 3
  s_mul_i32 s19, s10, 5120
  v_min_u32 v106, 39, v0
  v_mul_u32_u24 v107, 13, v106
  v_lshrrev_b32 v107, 6, v107
  v_mul_u32_u24 v98, 5, v107
  v_sub_u32 v98, v106, v98
  s_lshr_b32 s9, s75, 1
  v_mov_b32 v106, s9
  s_cmp_eq_u32 s2, 0
  s_cselect_b64 vcc, -1, 0
  v_cndmask_b32 v107, v106, v107, vcc
  v_add_u32 v107, 40, v107
  v_lshlrev_b32 v107, 8, v107
  v_lshl_add_u32 v98, v98, 2, v107
  s_mul_i32 s9, s76, 112
  s_add_u32 s10, s9, 111
  s_lshr_b32 s9, s9, 6
  s_lshr_b32 s10, s10, 6
  s_min_u32 s10, s10, 26
  v_lshrrev_b32 v106, 3, v0
  v_add_u32 v106, s9, v106
  v_min_u32 v106, s10, v106
  v_add_u32 v106, 8, v106
  v_lshlrev_b32 v106, 8, v106
  v_and_b32 v107, 7, v0
  v_lshl_add_u32 v99, v107, 2, v106
  s_lshl_b32 s9, s75, 2
  s_add_u32 s9, s9, s3
  s_mul_i32 s20, s9, 40960
  s_mul_i32 s9, s9, 110592
  s_mul_i32 s10, s76, 224
  s_add_u32 s21, s9, s10
  s_add_u32 s22, s21, 55296
  v_mul_u32_u24 v106, 3456, v2
  v_lshl_add_u32 v100, v1, 4, v106
  v_lshl_add_u32 v101, v1, 3, v106
  v_mov_b32 v107, 0x7f000000
  s_cmp_eq_u32 s76, 15
  s_cselect_b64 vcc, -1, 0
  v_cndmask_b32 v103, v100, v107, vcc
  v_cndmask_b32 v101, v101, v107, vcc
  s_mov_b32 vcc_lo, 0
  v_cndmask_b32 v102, v100, v107, vcc
  s_mul_i32 s76, s76, 143360
  s_lshr_b32 s9, s3, 1
  s_mul_i32 s9, s9, 20480
  s_and_b32 s10, s3, 1
  s_mul_i32 s23, s10, 5120
  s_add_u32 s23, s23, s9
  s_cmp_eq_u32 s10, 0
  s_cselect_b32 s24, s16, s17
  s_cselect_b32 s25, s18, s19
  s_cmp_lt_u32 s3, 2
  s_cselect_b32 s27, s24, s25
  s_add_u32 s27, s27, s76
  s_add_u32 s76, s76, s9
  s_add_u32 s24, s24, s76
  s_add_u32 s25, s25, s76
  s_mul_i32 s26, s3, 5120
  s_waitcnt vmcnt(0)
  s_barrier
  s_cmp_lg_u32 s3, 0
  s_cbranch_scc1 L_bnop
  v_mov_b32 v106, s78
  v_mov_b32 v107, s4
  s_mov_b64 exec, 1
  buffer_store_dword v107, v106, s[64:67], 0 offen sc1
  s_mov_b64 exec, -1
  s_mov_b32 s79, 400000
L_poll1:
  buffer_load_dword v124, v98, s[64:67], 0 offen sc1
  s_waitcnt vmcnt(0)
  v_cmp_ne_u32 vcc, s4, v124
  s_cmp_eq_u64 vcc, 0
  s_cbranch_scc1 L_pollok1
  s_sleep 1
  s_sub_u32 s79, s79, 1
  s_cmp_lg_u32 s79, 0
  s_cbranch_scc1 L_poll1
L_pollok1:
L_bnop:
  s_barrier
  s_branch L_loadx
L_phaseD:
  s_mov_b32 s79, 400000
L_poll2:
  buffer_load_dword v124, v98, s[64:67], 0 offen sc1
  s_waitcnt vmcnt(0)
  v_cmp_ne_u32 vcc, s4, v124
  s_cmp_eq_u64 vcc, 0
  s_cbranch_scc1 L_pollok2
  s_sleep 4
  s_sub_u32 s79, s79, 1
  s_cmp_lg_u32 s79, 0
  s_cbranch_scc1 L_poll2
L_pollok2:
L_loadx:
  s_add_u32 s9, s20, s16
  buffer_load_dwordx4 a[0:3], v96, s[40:43], s9 offen offset:0 sc1
  buffer_load_dwordx4 a[4:7], v96, s[40:43], s9 offen offset:1024 sc1
  buffer_load_dwordx4 a[8:11], v96, s[40:43], s9 offen offset:2048 sc1
  buffer_load_dwordx4 a[12:15], v96, s[40:43], s9 offen offset:3072 sc1
L_stub18:
  s_cbranch_execz L_scret
  buffer_load_dwordx4 a[16:19], v97, s[40:43], s9 offen sc1
  s_add_u32 s9, s20, s17
  buffer_load_dwordx4 a[20:23], v96, s[40:43], s9 offen offset:0 sc1
  buffer_load_dwordx4 a[24:27], v96, s[40:43], s9 offen offset:1024 sc1
  buffer_load_dwordx4 a[28:31], v96, s[40:43], s9 offen offset:2048 sc1
  buffer_load_dwordx4 a[32:35], v96, s[40:43], s9 offen offset:3072 sc1
  buffer_load_dwordx4 a[36:39], v97, s[40:43], s9 offen sc1
  s_add_u32 s9, s20, s18
  buffer_load_dwordx4 a[40:43], v96, s[40:43], s9 offen offset:0 sc1
  buffer_load_dwordx4 a[44:47], v96, s[40:43], s9 offen offset:1024 sc1
  buffer_load_dwordx4 a[48:51], v96, s[40:43], s9 offen offset:2048 sc1
  buffer_load_dwordx4 a[52:55], v96, s[40:43], s9 offen offset:3072 sc1
  buffer_load_dwordx4 a[56:59], v97, s[40:43], s9 offen sc1
  s_add_u32 s9, s20, s19
  buffer_load_dwordx4 a[60:63], v96, s[40:43], s9 offen offset:0 sc1
  buffer_load_dwordx4 a[64:67], v96, s[40:43], s9 offen offset:1024 sc1
  buffer_load_dwordx4 a[68:71], v96, s[40:43], s9 offen offset:2048 sc1
  buffer_load_dwordx4 a[72:75], v96, s[40:43], s9 offen offset:3072 sc1
  buffer_load_dwordx4 a[76:79], v97, s[40:43], s9 offen sc1
  s_add_u32 s9, s20, s16
  s_add_u32 s9, s9, 20480
  buffer_load_dwordx4 a[80:83], v96, s[40:43], s9 offen offset:0 sc1
  buffer_load_dwordx4 a[84:87], v96, s[40:43], s9 offen offset:1024 sc1
  buffer_load_dwordx4 a[88:91], v96, s[40:43], s9 offen offset:2048 sc1
  buffer_load_dwordx4 a[92:95], v96, s[40:43], s9 offen offset:3072 sc1
  buffer_load_dwordx4 a[96:99], v97, s[40:43], s9 offen sc1
  s_add_u32 s9, s20, s17
  s_add_u32 s9, s9, 20480
  buffer_load_dwordx4 a[100:103], v96, s[40:43], s9 offen offset:0 sc1
  buffer_load_dwordx4 a[104:107], v96, s[40:43], s9 offen offset:1024 sc1
  buffer_load_dwordx4 a[108:111], v96, s[40:43], s9 offen offset:2048 sc1
  buffer_load_dwordx4 a[112:115], v96, s[40:43], s9 offen offset:3072 sc1
  buffer_load_dwordx4 a[116:119], v97, s[40:43], s9 offen sc1
  s_add_u32 s9, s20, s18
  s_add_u32 s9, s9, 20480
  buffer_load_dwordx4 a[120:123], v96, s[40:43], s9 offen offset:0 sc1
  buffer_load_dword v124, v99, s[64:67], 0 offen sc1
  buffer_load_dwordx4 a[124:127], v96, s[40:43], s9 offen offset:1024 sc1
  buffer_load_dwordx4 a[128:131], v96, s[40:43], s9 offen offset:2048 sc1
  buffer_load_dwordx4 a[132:135], v96, s[40:43], s9 offen offset:3072 sc1
  buffer_load_dwordx4 a[136:139], v97, s[40:43], s9 offen sc1
  s_add_u32 s9, s20, s19
  s_add_u32 s9, s9, 20480
  buffer_load_dwordx4 a[140:143], v96, s[40:43], s9 offen offset:0 sc1
  buffer_load_dwordx4 a[144:147], v96, s[40:43], s9 offen offset:1024 sc1
  buffer_load_dwordx4 a[148:151], v96, s[40:43], s9 offen offset:2048 sc1
  buffer_load_dwordx4 a[152:155], v96, s[40:43], s9 offen offset:3072 sc1
  buffer_load_dwordx4 a[156:159], v97, s[40:43], s9 offen sc1
  s_cmp_lg_u32 s3, 0
  s_cbranch_scc1 L_nopollW
  s_waitcnt vmcnt(9)
  v_cmp_ne_u32 vcc, s4, v124
  s_cmp_eq_u64 vcc, 0
  s_cbranch_scc1 L_wok
  s_mov_b32 s79, 400000
L_poll3:
  buffer_load_dword v124, v99, s[64:67], 0 offen sc1
  s_waitcnt vmcnt(0)
  v_cmp_ne_u32 vcc, s4, v124
  s_cmp_eq_u64 vcc, 0
  s_cbranch_scc1 L_pollok3
  s_sleep 1
  s_sub_u32 s79, s79, 1
  s_cmp_lg_u32 s79, 0
  s_cbranch_scc1 L_poll3
L_pollok3:
L_wok:
  s_cmp_lg_u32 s2, 0
  s_cbranch_scc1 L_nopollW
  s_mov_b32 s9, 0x70000
  v_mov_b32 v106, s9
  v_mov_b32 v107, s4
  s_mov_b64 exec, 1
  buffer_store_dword v107, v106, s[64:67], 0 offen sc1
  s_mov_b64 exec, -1
L_nopollW:
  s_barrier
  s_add_u32 m0, s23, 0
  s_add_u32 s9, s24, 0
  buffer_load_dwordx4 v96, s[44:47], s9 offen offset:0 sc1 lds
  buffer_load_dwordx4 v96, s[44:47], s9 offen offset:1024 sc1 lds
  buffer_load_dwordx4 v96, s[44:47], s9 offen offset:2048 sc1 lds
  buffer_load_dwordx4 v96, s[44:47], s9 offen offset:3072 sc1 lds
  s_add_u32 m0, m0, 4096
  s_nop 0
  buffer_load_dwordx4 v97, s[44:47], s9 offen sc1 lds
  s_add_u32 m0, s23, 10240
  s_add_u32 s9, s25, 0
  buffer_load_dwordx4 v96, s[44:47], s9 offen offset:0 sc1 lds
  buffer_load_dwordx4 v96, s[44:47], s9 offen offset:1024 sc1 lds
  buffer_load_dwordx4 v96, s[44:47], s9 offen offset:2048 sc1 lds
  buffer_load_dwordx4 v96, s[44:47], s9 offen offset:3072 sc1 lds
  s_add_u32 m0, m0, 4096
  s_nop 0
  buffer_load_dwordx4 v97, s[44:47], s9 offen sc1 lds
  s_waitcnt vmcnt(5)
  s_barrier
  ds_read_b128 v[128:131], v96 offset:0
  ds_read_b128 v[132:135], v96 offset:20480
  ds_read_b128 v[136:139], v96 offset:1024
  ds_read_b128 v[140:143], v96 offset:21504
  ds_read_b128 v[144:147], v96 offset:2048
  ds_read_b128 v[148:151], v96 offset:22528
  s_waitcnt lgkmcnt(4)
  v_mfma_f32_16x16x32_bf16 v[32:35], v[128:131], a[0:3], 0
  ds_read_b128 v[152:155], v96 offset:3072
  v_mfma_f32_16x16x32_bf16 v[36:39], v[128:131], a[80:83], 0
  s_add_u32 m0, s23, 40960
  s_add_u32 s9, s24, 40960
  buffer_load_dwordx4 v96, s[44:47], s9 offen offset:0 sc1 lds
  v_mfma_f32_16x16x32_bf16 v[44:47], v[132:135], a[80:83], 0
  ds_read_b128 v[156:159], v96 offset:23552
  v_mfma_f32_16x16x32_bf16 v[40:43], v[132:135], a[0:3], 0
  s_waitcnt lgkmcnt(4)
  v_mfma_f32_16x16x32_bf16 v[32:35], v[136:139], a[4:7], v[32:35]
  ds_read_b128 v[128:131], v96 offset:4096
  v_mfma_f32_16x16x32_bf16 v[36:39], v[136:139], a[84:87], v[36:39]
  buffer_load_dwordx4 v96, s[44:47], s9 offen offset:1024 sc1 lds
  v_mfma_f32_16x16x32_bf16 v[44:47], v[140:143], a[84:87], v[44:47]
  ds_read_b128 v[132:135], v96 offset:24576
  v_mfma_f32_16x16x32_bf16 v[40:43], v[140:143], a[4:7], v[40:43]
  s_waitcnt lgkmcnt(4)
  v_mfma_f32_16x16x32_bf16 v[32:35], v[144:147], a[8:11], v[32:35]
  ds_read_b128 v[136:139], v96 offset:5120
  v_mfma_f32_16x16x32_bf16 v[36:39], v[144:147], a[88:91], v[36:39]
  buffer_load_dwordx4 v96, s[44:47], s9 offen offset:2048 sc1 lds
  v_mfma_f32_16x16x32_bf16 v[44:47], v[148:151], a[88:91], v[44:47]
  ds_read_b128 v[140:143], v96 offset:25600
  v_mfma_f32_16x16x32_bf16 v[40:43], v[148:151], a[8:11], v[40:43]
  s_waitcnt lgkmcnt(4)
  v_mfma_f32_16x16x32_bf16 v[32:35], v[152:155], a[12:15], v[32:35]
  ds_read_b128 v[144:147], v96 offset:6144
  v_mfma_f32_16x16x32_bf16 v[36:39], v[152:155], a[92:95], v[36:39]
  buffer_load_dwordx4 v96, s[44:47], s9 offen offset:3072 sc1 lds
  s_add_u32 m0, m0, 4096
  v_mfma_f32_16x16x32_bf16 v[44:47], v[156:159], a[92:95], v[44:47]
L_stub19:
  s_cbranch_execz L_scret
  ds_read_b128 v[148:151], v96 offset:26624
  v_mfma_f32_16x16x32_bf16 v[40:43], v[156:159], a[12:15], v[40:43]
  s_waitcnt lgkmcnt(4)
  v_mfma_f32_16x16x32_bf16 v[32:35], v[128:131], a[16:19], v[32:35]
  ds_read_b128 v[152:155], v96 offset:7168
  v_mfma_f32_16x16x32_bf16 v[36:39], v[128:131], a[96:99], v[36:39]
  buffer_load_dwordx4 v97, s[44:47], s9 offen sc1 lds
  v_mfma_f32_16x16x32_bf16 v[44:47], v[132:135], a[96:99], v[44:47]
  ds_read_b128 v[156:159], v96 offset:27648
  v_mfma_f32_16x16x32_bf16 v[40:43], v[132:135], a[16:19], v[40:43]
  s_waitcnt lgkmcnt(4)
  v_mfma_f32_16x16x32_bf16 v[32:35], v[136:139], a[20:23], v[32:35]
  ds_read_b128 v[128:131], v96 offset:8192
  v_mfma_f32_16x16x32_bf16 v[36:39], v[136:139], a[100:103], v[36:39]
  s_add_u32 m0, s23, 51200
  s_add_u32 s9, s25, 40960
  buffer_load_dwordx4 v96, s[44:47], s9 offen offset:0 sc1 lds
  v_mfma_f32_16x16x32_bf16 v[44:47], v[140:143], a[100:103], v[44:47]
  ds_read_b128 v[132:135], v96 offset:28672
  v_mfma_f32_16x16x32_bf16 v[40:43], v[140:143], a[20:23], v[40:43]
  s_waitcnt lgkmcnt(4)
  v_mfma_f32_16x16x32_bf16 v[32:35], v[144:147], a[24:27], v[32:35]
  ds_read_b128 v[136:139], v96 offset:9216
  v_mfma_f32_16x16x32_bf16 v[36:39], v[144:147], a[104:107], v[36:39]
  buffer_load_dwordx4 v96, s[44:47], s9 offen offset:1024 sc1 lds
  v_mfma_f32_16x16x32_bf16 v[44:47], v[148:151], a[104:107], v[44:47]
  ds_read_b128 v[140:143], v96 offset:29696
  v_mfma_f32_16x16x32_bf16 v[40:43], v[148:151], a[24:27], v[40:43]
  s_waitcnt vmcnt(7)
  s_barrier
  s_waitcnt lgkmcnt(4)
  v_mfma_f32_16x16x32_bf16 v[32:35], v[152:155], a[28:31], v[32:35]
  ds_read_b128 v[144:147], v96 offset:10240
  v_mfma_f32_16x16x32_bf16 v[36:39], v[152:155], a[108:111], v[36:39]
  buffer_load_dwordx4 v96, s[44:47], s9 offen offset:2048 sc1 lds
  v_mfma_f32_16x16x32_bf16 v[44:47], v[156:159], a[108:111], v[44:47]
  ds_read_b128 v[148:151], v96 offset:30720
  v_mfma_f32_16x16x32_bf16 v[40:43], v[156:159], a[28:31], v[40:43]
  s_waitcnt lgkmcnt(4)
  v_mfma_f32_16x16x32_bf16 v[32:35], v[128:131], a[32:35], v[32:35]
  ds_read_b128 v[152:155], v96 offset:11264
  v_mfma_f32_16x16x32_bf16 v[36:39], v[128:131], a[112:115], v[36:39]
  buffer_load_dwordx4 v96, s[44:47], s9 offen offset:3072 sc1 lds
  s_add_u32 m0, m0, 4096
  v_mfma_f32_16x16x32_bf16 v[44:47], v[132:135], a[112:115], v[44:47]
  ds_read_b128 v[156:159], v96 offset:31744
  v_mfma_f32_16x16x32_bf16 v[40:43], v[132:135], a[32:35], v[40:43]
  s_waitcnt lgkmcnt(4)
  v_mfma_f32_16x16x32_bf16 v[32:35], v[136:139], a[36:39], v[32:35]
  ds_read_b128 v[128:131], v96 offset:12288
  v_mfma_f32_16x16x32_bf16 v[36:39], v[136:139], a[116:119], v[36:39]
  buffer_load_dwordx4 v97, s[44:47], s9 offen sc1 lds
  v_mfma_f32_16x16x32_bf16 v[44:47], v[140:143], a[116:119], v[44:47]
  ds_read_b128 v[132:135], v96 offset:32768
  v_mfma_f32_16x16x32_bf16 v[40:43], v[140:143], a[36:39], v[40:43]
  s_waitcnt lgkmcnt(4)
  v_mfma_f32_16x16x32_bf16 v[32:35], v[144:147], a[40:43], v[32:35]
  ds_read_b128 v[136:139], v96 offset:13312
  v_mfma_f32_16x16x32_bf16 v[36:39], v[144:147], a[120:123], v[36:39]
  s_add_u32 m0, s23, 81920
  s_add_u32 s9, s24, 81920
  buffer_load_dwordx4 v96, s[44:47], s9 offen offset:0 sc1 lds
  v_mfma_f32_16x16x32_bf16 v[44:47], v[148:151], a[120:123], v[44:47]
  ds_read_b128 v[140:143], v96 offset:33792
  v_mfma_f32_16x16x32_bf16 v[40:43], v[148:151], a[40:43], v[40:43]
  s_waitcnt lgkmcnt(4)
  v_mfma_f32_16x16x32_bf16 v[32:35], v[152:155], a[44:47], v[32:35]
  ds_read_b128 v[144:147], v96 offset:14336
  v_mfma_f32_16x16x32_bf16 v[36:39], v[152:155], a[124:127], v[36:39]
  buffer_load_dwordx4 v96, s[44:47], s9 offen offset:1024 sc1 lds
  v_mfma_f32_16x16x32_bf16 v[44:47], v[156:159], a[124:127], v[44:47]
  ds_read_b128 v[148:151], v96 offset:34816
  v_mfma_f32_16x16x32_bf16 v[40:43], v[156:159], a[44:47], v[40:43]
  s_waitcnt lgkmcnt(4)
  v_mfma_f32_16x16x32_bf16 v[32:35], v[128:131], a[48:51], v[32:35]
  ds_read_b128 v[152:155], v96 offset:15360
  v_mfma_f32_16x16x32_bf16 v[36:39], v[128:131], a[128:131], v[36:39]
  buffer_load_dwordx4 v96, s[44:47], s9 offen offset:2048 sc1 lds
  v_mfma_f32_16x16x32_bf16 v[44:47], v[132:135], a[128:131], v[44:47]
  ds_read_b128 v[156:159], v96 offset:35840
  v_mfma_f32_16x16x32_bf16 v[40:43], v[132:135], a[48:51], v[40:43]
  s_waitcnt lgkmcnt(4)
  v_mfma_f32_16x16x32_bf16 v[32:35], v[136:139], a[52:55], v[32:35]
  ds_read_b128 v[128:131], v96 offset:16384
  v_mfma_f32_16x16x32_bf16 v[36:39], v[136:139], a[132:135], v[36:39]
  buffer_load_dwordx4 v96, s[44:47], s9 offen offset:3072 sc1 lds
  s_add_u32 m0, m0, 4096
  v_mfma_f32_16x16x32_bf16 v[44:47], v[140:143], a[132:135], v[44:47]
  ds_read_b128 v[132:135], v96 offset:36864
  v_mfma_f32_16x16x32_bf16 v[40:43], v[140:143], a[52:55], v[40:43]
  s_waitcnt lgkmcnt(4)
  v_mfma_f32_16x16x32_bf16 v[32:35], v[144:147], a[56:59], v[32:35]
  ds_read_b128 v[136:139], v96 offset:17408
  v_mfma_f32_16x16x32_bf16 v[36:39], v[144:147], a[136:139], v[36:39]
  buffer_load_dwordx4 v97, s[44:47], s9 offen sc1 lds
  v_mfma_f32_16x16x32_bf16 v[44:47], v[148:151], a[136:139], v[44:47]
  ds_read_b128 v[140:143], v96 offset:37888
  v_mfma_f32_16x16x32_bf16 v[40:43], v[148:151], a[56:59], v[40:43]
  s_waitcnt lgkmcnt(4)
  v_mfma_f32_16x16x32_bf16 v[32:35], v[152:155], a[60:63], v[32:35]
  ds_read_b128 v[144:147], v96 offset:18432
  v_mfma_f32_16x16x32_bf16 v[36:39], v[152:155], a[140:143], v[36:39]
  s_add_u32 m0, s23, 92160
  s_add_u32 s9, s25, 81920
  buffer_load_dwordx4 v96, s[44:47], s9 offen offset:0 sc1 lds
  v_mfma_f32_16x16x32_bf16 v[44:47], v[156:159], a[140:143], v[44:47]
  ds_read_b128 v[148:151], v96 offset:38912
  v_mfma_f32_16x16x32_bf16 v[40:43], v[156:159], a[60:63], v[40:43]
  s_waitcnt lgkmcnt(4)
  v_mfma_f32_16x16x32_bf16 v[32:35], v[128:131], a[64:67], v[32:35]
  ds_read_b128 v[152:155], v96 offset:19456
  v_mfma_f32_16x16x32_bf16 v[36:39], v[128:131], a[144:147], v[36:39]
  buffer_load_dwordx4 v96, s[44:47], s9 offen offset:1024 sc1 lds
  v_mfma_f32_16x16x32_bf16 v[44:47], v[132:135], a[144:147], v[44:47]
  ds_read_b128 v[156:159], v96 offset:39936
  v_mfma_f32_16x16x32_bf16 v[40:43], v[132:135], a[64:67], v[40:43]
  s_waitcnt vmcnt(12)
  s_barrier
  s_waitcnt lgkmcnt(4)
  v_mfma_f32_16x16x32_bf16 v[32:35], v[136:139], a[68:71], v[32:35]
  ds_read_b128 v[128:131], v96 offset:40960
  v_mfma_f32_16x16x32_bf16 v[36:39], v[136:139], a[148:151], v[36:39]
L_stub20:
  s_cbranch_execz L_scret
  buffer_load_dwordx4 v96, s[44:47], s9 offen offset:2048 sc1 lds
  v_mfma_f32_16x16x32_bf16 v[44:47], v[140:143], a[148:151], v[44:47]
  ds_read_b128 v[132:135], v96 offset:61440
  v_mfma_f32_16x16x32_bf16 v[40:43], v[140:143], a[68:71], v[40:43]
  s_waitcnt lgkmcnt(4)
  v_mfma_f32_16x16x32_bf16 v[32:35], v[144:147], a[72:75], v[32:35]
  ds_read_b128 v[136:139], v96 offset:41984
  v_mfma_f32_16x16x32_bf16 v[36:39], v[144:147], a[152:155], v[36:39]
  buffer_load_dwordx4 v96, s[44:47], s9 offen offset:3072 sc1 lds
  s_add_u32 m0, m0, 4096
  v_mfma_f32_16x16x32_bf16 v[44:47], v[148:151], a[152:155], v[44:47]
  ds_read_b128 v[140:143], v96 offset:62464
  v_mfma_f32_16x16x32_bf16 v[40:43], v[148:151], a[72:75], v[40:43]
  s_waitcnt lgkmcnt(4)
  v_mfma_f32_16x16x32_bf16 v[32:35], v[152:155], a[76:79], v[32:35]
  ds_read_b128 v[144:147], v96 offset:43008
  v_mfma_f32_16x16x32_bf16 v[36:39], v[152:155], a[156:159], v[36:39]
  buffer_load_dwordx4 v97, s[44:47], s9 offen sc1 lds
  v_mfma_f32_16x16x32_bf16 v[44:47], v[156:159], a[156:159], v[44:47]
  ds_read_b128 v[148:151], v96 offset:63488
  v_mfma_f32_16x16x32_bf16 v[40:43], v[156:159], a[76:79], v[40:43]
  s_waitcnt lgkmcnt(4)
  v_mfma_f32_16x16x32_bf16 v[48:51], v[128:131], a[0:3], 0
  ds_read_b128 v[152:155], v96 offset:44032
  v_mfma_f32_16x16x32_bf16 v[52:55], v[128:131], a[80:83], 0
  s_add_u32 m0, s26, 122880
  s_add_u32 s9, s27, 122880
  buffer_load_dwordx4 v96, s[44:47], s9 offen offset:0 sc1 lds
  v_mfma_f32_16x16x32_bf16 v[60:63], v[132:135], a[80:83], 0
  ds_read_b128 v[156:159], v96 offset:64512
  v_mfma_f32_16x16x32_bf16 v[56:59], v[132:135], a[0:3], 0
  s_waitcnt lgkmcnt(4)
  v_mfma_f32_16x16x32_bf16 v[48:51], v[136:139], a[4:7], v[48:51]
  ds_read_b128 v[128:131], v96 offset:45056
  v_mfma_f32_16x16x32_bf16 v[52:55], v[136:139], a[84:87], v[52:55]
  buffer_load_dwordx4 v96, s[44:47], s9 offen offset:1024 sc1 lds
  v_mfma_f32_16x16x32_bf16 v[60:63], v[140:143], a[84:87], v[60:63]
  ds_read_b128 v[132:135], v104 offset:0
  v_mfma_f32_16x16x32_bf16 v[56:59], v[140:143], a[4:7], v[56:59]
  s_waitcnt lgkmcnt(4)
  v_mfma_f32_16x16x32_bf16 v[48:51], v[144:147], a[8:11], v[48:51]
  ds_read_b128 v[136:139], v96 offset:46080
  v_mfma_f32_16x16x32_bf16 v[52:55], v[144:147], a[88:91], v[52:55]
  buffer_load_dwordx4 v96, s[44:47], s9 offen offset:2048 sc1 lds
  v_mfma_f32_16x16x32_bf16 v[60:63], v[148:151], a[88:91], v[60:63]
  ds_read_b128 v[140:143], v104 offset:1024
  v_mfma_f32_16x16x32_bf16 v[56:59], v[148:151], a[8:11], v[56:59]
  s_waitcnt lgkmcnt(4)
  v_mfma_f32_16x16x32_bf16 v[48:51], v[152:155], a[12:15], v[48:51]
  ds_read_b128 v[144:147], v96 offset:47104
  v_mfma_f32_16x16x32_bf16 v[52:55], v[152:155], a[92:95], v[52:55]
  buffer_load_dwordx4 v96, s[44:47], s9 offen offset:3072 sc1 lds
  s_add_u32 m0, m0, 4096
  v_mfma_f32_16x16x32_bf16 v[60:63], v[156:159], a[92:95], v[60:63]
  ds_read_b128 v[148:151], v104 offset:2048
  v_mfma_f32_16x16x32_bf16 v[56:59], v[156:159], a[12:15], v[56:59]
  s_waitcnt lgkmcnt(4)
  v_mfma_f32_16x16x32_bf16 v[48:51], v[128:131], a[16:19], v[48:51]
  ds_read_b128 v[152:155], v96 offset:48128
  v_mfma_f32_16x16x32_bf16 v[52:55], v[128:131], a[96:99], v[52:55]
  buffer_load_dwordx4 v97, s[44:47], s9 offen sc1 lds
  v_mfma_f32_16x16x32_bf16 v[60:63], v[132:135], a[96:99], v[60:63]
  ds_read_b128 v[156:159], v104 offset:3072
  v_mfma_f32_16x16x32_bf16 v[56:59], v[132:135], a[16:19], v[56:59]
  s_waitcnt lgkmcnt(4)
  v_mfma_f32_16x16x32_bf16 v[48:51], v[136:139], a[20:23], v[48:51]
  ds_read_b128 v[128:131], v96 offset:49152
  v_mfma_f32_16x16x32_bf16 v[52:55], v[136:139], a[100:103], v[52:55]
  v_mfma_f32_16x16x32_bf16 v[60:63], v[140:143], a[100:103], v[60:63]
  ds_read_b128 v[132:135], v104 offset:4096
  v_mfma_f32_16x16x32_bf16 v[56:59], v[140:143], a[20:23], v[56:59]
  s_waitcnt lgkmcnt(4)
  v_mfma_f32_16x16x32_bf16 v[48:51], v[144:147], a[24:27], v[48:51]
  ds_read_b128 v[136:139], v96 offset:50176
  v_mfma_f32_16x16x32_bf16 v[52:55], v[144:147], a[104:107], v[52:55]
  v_mfma_f32_16x16x32_bf16 v[60:63], v[148:151], a[104:107], v[60:63]
  ds_read_b128 v[140:143], v104 offset:5120
  v_mfma_f32_16x16x32_bf16 v[56:59], v[148:151], a[24:27], v[56:59]
  s_waitcnt vmcnt(15)
  s_barrier
  s_waitcnt lgkmcnt(4)
  v_mfma_f32_16x16x32_bf16 v[48:51], v[152:155], a[28:31], v[48:51]
  ds_read_b128 v[144:147], v96 offset:51200
  v_mfma_f32_16x16x32_bf16 v[52:55], v[152:155], a[108:111], v[52:55]
  v_mfma_f32_16x16x32_bf16 v[60:63], v[156:159], a[108:111], v[60:63]
  ds_read_b128 v[148:151], v104 offset:6144
  v_mfma_f32_16x16x32_bf16 v[56:59], v[156:159], a[28:31], v[56:59]
  s_waitcnt lgkmcnt(4)
  v_mfma_f32_16x16x32_bf16 v[48:51], v[128:131], a[32:35], v[48:51]
  ds_read_b128 v[152:155], v96 offset:52224
  v_mfma_f32_16x16x32_bf16 v[52:55], v[128:131], a[112:115], v[52:55]
  v_mfma_f32_16x16x32_bf16 v[60:63], v[132:135], a[112:115], v[60:63]
  ds_read_b128 v[156:159], v104 offset:7168
  v_mfma_f32_16x16x32_bf16 v[56:59], v[132:135], a[32:35], v[56:59]
  s_waitcnt lgkmcnt(4)
  v_mfma_f32_16x16x32_bf16 v[48:51], v[136:139], a[36:39], v[48:51]
  ds_read_b128 v[128:131], v96 offset:53248
  v_mfma_f32_16x16x32_bf16 v[52:55], v[136:139], a[116:119], v[52:55]
  v_mfma_f32_16x16x32_bf16 v[60:63], v[140:143], a[116:119], v[60:63]
  ds_read_b128 v[132:135], v104 offset:8192
  v_mfma_f32_16x16x32_bf16 v[56:59], v[140:143], a[36:39], v[56:59]
  s_waitcnt lgkmcnt(4)
  v_mfma_f32_16x16x32_bf16 v[48:51], v[144:147], a[40:43], v[48:51]
  ds_read_b128 v[136:139], v96 offset:54272
  v_mfma_f32_16x16x32_bf16 v[52:55], v[144:147], a[120:123], v[52:55]
  v_cvt_pk_bf16_f32 v108, v32, v33
  v_mfma_f32_16x16x32_bf16 v[60:63], v[148:151], a[120:123], v[60:63]
  ds_read_b128 v[140:143], v104 offset:9216
  v_mfma_f32_16x16x32_bf16 v[56:59], v[148:151], a[40:43], v[56:59]
  v_cvt_pk_bf16_f32 v109, v34, v35
  s_waitcnt lgkmcnt(4)
  v_mfma_f32_16x16x32_bf16 v[48:51], v[152:155], a[44:47], v[48:51]
  ds_read_b128 v[144:147], v96 offset:55296
  v_mfma_f32_16x16x32_bf16 v[52:55], v[152:155], a[124:127], v[52:55]
  v_cvt_pk_bf16_f32 v110, v40, v41
  v_mfma_f32_16x16x32_bf16 v[60:63], v[156:159], a[124:127], v[60:63]
  ds_read_b128 v[148:151], v104 offset:10240
  v_mfma_f32_16x16x32_bf16 v[56:59], v[156:159], a[44:47], v[56:59]
  v_cvt_pk_bf16_f32 v111, v42, v43
  s_waitcnt lgkmcnt(4)
  v_mfma_f32_16x16x32_bf16 v[48:51], v[128:131], a[48:51], v[48:51]
L_stub21:
  s_cbranch_execz L_scret
  ds_read_b128 v[152:155], v96 offset:56320
  v_mfma_f32_16x16x32_bf16 v[52:55], v[128:131], a[128:131], v[52:55]
  buffer_store_dwordx4 v[108:111], v100, s[68:71], s21 offen offset:0
  v_mfma_f32_16x16x32_bf16 v[60:63], v[132:135], a[128:131], v[60:63]
  ds_read_b128 v[156:159], v104 offset:11264
  v_mfma_f32_16x16x32_bf16 v[56:59], v[132:135], a[48:51], v[56:59]
  v_cvt_pk_bf16_f32 v112, v36, v37
  s_waitcnt lgkmcnt(4)
  v_mfma_f32_16x16x32_bf16 v[48:51], v[136:139], a[52:55], v[48:51]
  ds_read_b128 v[128:131], v96 offset:57344
  v_mfma_f32_16x16x32_bf16 v[52:55], v[136:139], a[132:135], v[52:55]
  v_cvt_pk_bf16_f32 v113, v38, v39
  v_mfma_f32_16x16x32_bf16 v[60:63], v[140:143], a[132:135], v[60:63]
  ds_read_b128 v[132:135], v104 offset:12288
  v_mfma_f32_16x16x32_bf16 v[56:59], v[140:143], a[52:55], v[56:59]
  v_cvt_pk_bf16_f32 v114, v44, v45
  s_waitcnt lgkmcnt(4)
  v_mfma_f32_16x16x32_bf16 v[48:51], v[144:147], a[56:59], v[48:51]
  ds_read_b128 v[136:139], v96 offset:58368
  v_mfma_f32_16x16x32_bf16 v[52:55], v[144:147], a[136:139], v[52:55]
  v_cvt_pk_bf16_f32 v115, v46, v47
  v_mfma_f32_16x16x32_bf16 v[60:63], v[148:151], a[136:139], v[60:63]
  ds_read_b128 v[140:143], v104 offset:13312
  v_mfma_f32_16x16x32_bf16 v[56:59], v[148:151], a[56:59], v[56:59]
  buffer_store_dwordx4 v[112:115], v100, s[68:71], s22 offen offset:0
  s_waitcnt lgkmcnt(4)
  v_mfma_f32_16x16x32_bf16 v[48:51], v[152:155], a[60:63], v[48:51]
  ds_read_b128 v[144:147], v96 offset:59392
  v_mfma_f32_16x16x32_bf16 v[52:55], v[152:155], a[140:143], v[52:55]
  v_mfma_f32_16x16x32_bf16 v[60:63], v[156:159], a[140:143], v[60:63]
  ds_read_b128 v[148:151], v104 offset:14336
  v_mfma_f32_16x16x32_bf16 v[56:59], v[156:159], a[60:63], v[56:59]
  s_waitcnt lgkmcnt(4)
  v_mfma_f32_16x16x32_bf16 v[48:51], v[128:131], a[64:67], v[48:51]
  ds_read_b128 v[152:155], v96 offset:60416
  v_mfma_f32_16x16x32_bf16 v[52:55], v[128:131], a[144:147], v[52:55]
  v_mfma_f32_16x16x32_bf16 v[60:63], v[132:135], a[144:147], v[60:63]
  ds_read_b128 v[156:159], v104 offset:15360
  v_mfma_f32_16x16x32_bf16 v[56:59], v[132:135], a[64:67], v[56:59]
  s_waitcnt vmcnt(2)
  s_barrier
  s_waitcnt lgkmcnt(4)
  v_mfma_f32_16x16x32_bf16 v[48:51], v[136:139], a[68:71], v[48:51]
  ds_read_b128 v[128:131], v104 offset:16384
  v_mfma_f32_16x16x32_bf16 v[52:55], v[136:139], a[148:151], v[52:55]
  v_mfma_f32_16x16x32_bf16 v[60:63], v[140:143], a[148:151], v[60:63]
  ds_read_b128 v[132:135], v104 offset:36864
  v_mfma_f32_16x16x32_bf16 v[56:59], v[140:143], a[68:71], v[56:59]
  s_waitcnt lgkmcnt(4)
  v_mfma_f32_16x16x32_bf16 v[48:51], v[144:147], a[72:75], v[48:51]
  ds_read_b128 v[136:139], v104 offset:17408
  v_mfma_f32_16x16x32_bf16 v[52:55], v[144:147], a[152:155], v[52:55]
  v_mfma_f32_16x16x32_bf16 v[60:63], v[148:151], a[152:155], v[60:63]
  ds_read_b128 v[140:143], v104 offset:37888
  v_mfma_f32_16x16x32_bf16 v[56:59], v[148:151], a[72:75], v[56:59]
  s_waitcnt lgkmcnt(4)
  v_mfma_f32_16x16x32_bf16 v[48:51], v[152:155], a[76:79], v[48:51]
  ds_read_b128 v[144:147], v104 offset:18432
  v_mfma_f32_16x16x32_bf16 v[52:55], v[152:155], a[156:159], v[52:55]
  v_mfma_f32_16x16x32_bf16 v[60:63], v[156:159], a[156:159], v[60:63]
  ds_read_b128 v[148:151], v104 offset:38912
  v_mfma_f32_16x16x32_bf16 v[56:59], v[156:159], a[76:79], v[56:59]
  s_waitcnt lgkmcnt(4)
  v_mfma_f32_16x16x32_bf16 v[32:35], v[128:131], a[0:3], 0
  ds_read_b128 v[152:155], v104 offset:19456
  v_mfma_f32_16x16x32_bf16 v[36:39], v[128:131], a[80:83], 0
  v_mfma_f32_16x16x32_bf16 v[44:47], v[132:135], a[80:83], 0
  ds_read_b128 v[156:159], v104 offset:39936
  v_mfma_f32_16x16x32_bf16 v[40:43], v[132:135], a[0:3], 0
  s_waitcnt lgkmcnt(4)
  v_mfma_f32_16x16x32_bf16 v[32:35], v[136:139], a[4:7], v[32:35]
  ds_read_b128 v[128:131], v104 offset:20480
  v_mfma_f32_16x16x32_bf16 v[36:39], v[136:139], a[84:87], v[36:39]
  v_mfma_f32_16x16x32_bf16 v[44:47], v[140:143], a[84:87], v[44:47]
  ds_read_b128 v[132:135], v104 offset:40960
  v_mfma_f32_16x16x32_bf16 v[40:43], v[140:143], a[4:7], v[40:43]
  s_waitcnt lgkmcnt(4)
  v_mfma_f32_16x16x32_bf16 v[32:35], v[144:147], a[8:11], v[32:35]
  ds_read_b128 v[136:139], v104 offset:21504
  v_mfma_f32_16x16x32_bf16 v[36:39], v[144:147], a[88:91], v[36:39]
  v_mfma_f32_16x16x32_bf16 v[44:47], v[148:151], a[88:91], v[44:47]
  ds_read_b128 v[140:143], v104 offset:41984
  v_mfma_f32_16x16x32_bf16 v[40:43], v[148:151], a[8:11], v[40:43]
  s_waitcnt lgkmcnt(4)
  v_mfma_f32_16x16x32_bf16 v[32:35], v[152:155], a[12:15], v[32:35]
  ds_read_b128 v[144:147], v104 offset:22528
  v_mfma_f32_16x16x32_bf16 v[36:39], v[152:155], a[92:95], v[36:39]
  v_cvt_pk_bf16_f32 v108, v48, v49
  v_mfma_f32_16x16x32_bf16 v[44:47], v[156:159], a[92:95], v[44:47]
  ds_read_b128 v[148:151], v104 offset:43008
  v_mfma_f32_16x16x32_bf16 v[40:43], v[156:159], a[12:15], v[40:43]
  v_cvt_pk_bf16_f32 v109, v50, v51
  s_waitcnt lgkmcnt(4)
  v_mfma_f32_16x16x32_bf16 v[32:35], v[128:131], a[16:19], v[32:35]
  ds_read_b128 v[152:155], v104 offset:23552
  v_mfma_f32_16x16x32_bf16 v[36:39], v[128:131], a[96:99], v[36:39]
  v_cvt_pk_bf16_f32 v110, v56, v57
  v_mfma_f32_16x16x32_bf16 v[44:47], v[132:135], a[96:99], v[44:47]
  ds_read_b128 v[156:159], v104 offset:44032
  v_mfma_f32_16x16x32_bf16 v[40:43], v[132:135], a[16:19], v[40:43]
  v_cvt_pk_bf16_f32 v111, v58, v59
  s_waitcnt lgkmcnt(4)
  v_mfma_f32_16x16x32_bf16 v[32:35], v[136:139], a[20:23], v[32:35]
  ds_read_b128 v[128:131], v104 offset:24576
  v_mfma_f32_16x16x32_bf16 v[36:39], v[136:139], a[100:103], v[36:39]
  buffer_store_dwordx4 v[108:111], v102, s[68:71], s21 offen offset:64
  v_mfma_f32_16x16x32_bf16 v[44:47], v[140:143], a[100:103], v[44:47]
  ds_read_b128 v[132:135], v104 offset:45056
  v_mfma_f32_16x16x32_bf16 v[40:43], v[140:143], a[20:23], v[40:43]
  v_cvt_pk_bf16_f32 v112, v52, v53
  s_waitcnt lgkmcnt(4)
  v_mfma_f32_16x16x32_bf16 v[32:35], v[144:147], a[24:27], v[32:35]
  ds_read_b128 v[136:139], v104 offset:25600
  v_mfma_f32_16x16x32_bf16 v[36:39], v[144:147], a[104:107], v[36:39]
  v_cvt_pk_bf16_f32 v113, v54, v55
  v_mfma_f32_16x16x32_bf16 v[44:47], v[148:151], a[104:107], v[44:47]
  ds_read_b128 v[140:143], v104 offset:46080
  v_mfma_f32_16x16x32_bf16 v[40:43], v[148:151], a[24:27], v[40:43]
  v_cvt_pk_bf16_f32 v114, v60, v61
  s_waitcnt lgkmcnt(4)
  v_mfma_f32_16x16x32_bf16 v[32:35], v[152:155], a[28:31], v[32:35]
L_stub22:
  s_cbranch_execz L_scret
  ds_read_b128 v[144:147], v104 offset:26624
  v_mfma_f32_16x16x32_bf16 v[36:39], v[152:155], a[108:111], v[36:39]
  v_cvt_pk_bf16_f32 v115, v62, v63
  v_mfma_f32_16x16x32_bf16 v[44:47], v[156:159], a[108:111], v[44:47]
  ds_read_b128 v[148:151], v104 offset:47104
  v_mfma_f32_16x16x32_bf16 v[40:43], v[156:159], a[28:31], v[40:43]
  buffer_store_dwordx4 v[112:115], v102, s[68:71], s22 offen offset:64
  s_waitcnt lgkmcnt(4)
  v_mfma_f32_16x16x32_bf16 v[32:35], v[128:131], a[32:35], v[32:35]
  ds_read_b128 v[152:155], v104 offset:27648
  v_mfma_f32_16x16x32_bf16 v[36:39], v[128:131], a[112:115], v[36:39]
  v_mfma_f32_16x16x32_bf16 v[44:47], v[132:135], a[112:115], v[44:47]
  ds_read_b128 v[156:159], v104 offset:48128
  v_mfma_f32_16x16x32_bf16 v[40:43], v[132:135], a[32:35], v[40:43]
  s_waitcnt lgkmcnt(4)
  v_mfma_f32_16x16x32_bf16 v[32:35], v[136:139], a[36:39], v[32:35]
  ds_read_b128 v[128:131], v104 offset:28672
  v_mfma_f32_16x16x32_bf16 v[36:39], v[136:139], a[116:119], v[36:39]
  v_mfma_f32_16x16x32_bf16 v[44:47], v[140:143], a[116:119], v[44:47]
  ds_read_b128 v[132:135], v104 offset:49152
  v_mfma_f32_16x16x32_bf16 v[40:43], v[140:143], a[36:39], v[40:43]
  s_waitcnt lgkmcnt(4)
  v_mfma_f32_16x16x32_bf16 v[32:35], v[144:147], a[40:43], v[32:35]
  ds_read_b128 v[136:139], v104 offset:29696
  v_mfma_f32_16x16x32_bf16 v[36:39], v[144:147], a[120:123], v[36:39]
  v_mfma_f32_16x16x32_bf16 v[44:47], v[148:151], a[120:123], v[44:47]
  ds_read_b128 v[140:143], v104 offset:50176
  v_mfma_f32_16x16x32_bf16 v[40:43], v[148:151], a[40:43], v[40:43]
  s_waitcnt lgkmcnt(4)
  v_mfma_f32_16x16x32_bf16 v[32:35], v[152:155], a[44:47], v[32:35]
  ds_read_b128 v[144:147], v104 offset:30720
  v_mfma_f32_16x16x32_bf16 v[36:39], v[152:155], a[124:127], v[36:39]
  v_mfma_f32_16x16x32_bf16 v[44:47], v[156:159], a[124:127], v[44:47]
  ds_read_b128 v[148:151], v104 offset:51200
  v_mfma_f32_16x16x32_bf16 v[40:43], v[156:159], a[44:47], v[40:43]
  s_waitcnt lgkmcnt(4)
  v_mfma_f32_16x16x32_bf16 v[32:35], v[128:131], a[48:51], v[32:35]
  ds_read_b128 v[152:155], v104 offset:31744
  v_mfma_f32_16x16x32_bf16 v[36:39], v[128:131], a[128:131], v[36:39]
  v_mfma_f32_16x16x32_bf16 v[44:47], v[132:135], a[128:131], v[44:47]
  ds_read_b128 v[156:159], v104 offset:52224
  v_mfma_f32_16x16x32_bf16 v[40:43], v[132:135], a[48:51], v[40:43]
  s_waitcnt lgkmcnt(4)
  v_mfma_f32_16x16x32_bf16 v[32:35], v[136:139], a[52:55], v[32:35]
  ds_read_b128 v[128:131], v104 offset:32768
  v_mfma_f32_16x16x32_bf16 v[36:39], v[136:139], a[132:135], v[36:39]
  v_mfma_f32_16x16x32_bf16 v[44:47], v[140:143], a[132:135], v[44:47]
  ds_read_b128 v[132:135], v104 offset:53248
  v_mfma_f32_16x16x32_bf16 v[40:43], v[140:143], a[52:55], v[40:43]
  s_waitcnt lgkmcnt(4)
  v_mfma_f32_16x16x32_bf16 v[32:35], v[144:147], a[56:59], v[32:35]
  ds_read_b128 v[136:139], v104 offset:33792
  v_mfma_f32_16x16x32_bf16 v[36:39], v[144:147], a[136:139], v[36:39]
  v_mfma_f32_16x16x32_bf16 v[44:47], v[148:151], a[136:139], v[44:47]
  ds_read_b128 v[140:143], v104 offset:54272
  v_mfma_f32_16x16x32_bf16 v[40:43], v[148:151], a[56:59], v[40:43]
  s_waitcnt lgkmcnt(4)
  v_mfma_f32_16x16x32_bf16 v[32:35], v[152:155], a[60:63], v[32:35]
  ds_read_b128 v[144:147], v104 offset:34816
  v_mfma_f32_16x16x32_bf16 v[36:39], v[152:155], a[140:143], v[36:39]
  v_mfma_f32_16x16x32_bf16 v[44:47], v[156:159], a[140:143], v[44:47]
  ds_read_b128 v[148:151], v104 offset:55296
  v_mfma_f32_16x16x32_bf16 v[40:43], v[156:159], a[60:63], v[40:43]
  s_waitcnt lgkmcnt(4)
  v_mfma_f32_16x16x32_bf16 v[32:35], v[128:131], a[64:67], v[32:35]
  ds_read_b128 v[152:155], v104 offset:35840
  v_mfma_f32_16x16x32_bf16 v[36:39], v[128:131], a[144:147], v[36:39]
  v_mfma_f32_16x16x32_bf16 v[44:47], v[132:135], a[144:147], v[44:47]
  ds_read_b128 v[156:159], v104 offset:56320
  v_mfma_f32_16x16x32_bf16 v[40:43], v[132:135], a[64:67], v[40:43]
  s_waitcnt lgkmcnt(4)
  v_mfma_f32_16x16x32_bf16 v[32:35], v[136:139], a[68:71], v[32:35]
  ds_read_b128 v[128:131], v104 offset:57344
  v_mfma_f32_16x16x32_bf16 v[36:39], v[136:139], a[148:151], v[36:39]
  v_mfma_f32_16x16x32_bf16 v[44:47], v[140:143], a[148:151], v[44:47]
  ds_read_b128 v[132:135], v104 offset:58368
  v_mfma_f32_16x16x32_bf16 v[40:43], v[140:143], a[68:71], v[40:43]
  s_waitcnt lgkmcnt(4)
  v_mfma_f32_16x16x32_bf16 v[32:35], v[144:147], a[72:75], v[32:35]
  ds_read_b128 v[136:139], v104 offset:59392
  v_mfma_f32_16x16x32_bf16 v[36:39], v[144:147], a[152:155], v[36:39]
  v_mfma_f32_16x16x32_bf16 v[44:47], v[148:151], a[152:155], v[44:47]
  ds_read_b128 v[140:143], v104 offset:60416
  v_mfma_f32_16x16x32_bf16 v[40:43], v[148:151], a[72:75], v[40:43]
  s_waitcnt lgkmcnt(4)
  v_mfma_f32_16x16x32_bf16 v[32:35], v[152:155], a[76:79], v[32:35]
  ds_read_b128 v[144:147], v104 offset:61440
  v_mfma_f32_16x16x32_bf16 v[36:39], v[152:155], a[156:159], v[36:39]
  v_mfma_f32_16x16x32_bf16 v[44:47], v[156:159], a[156:159], v[44:47]
  ds_read_b128 v[148:151], v104 offset:62464
  v_mfma_f32_16x16x32_bf16 v[40:43], v[156:159], a[76:79], v[40:43]
  s_waitcnt lgkmcnt(4)
  v_mfma_f32_16x16x32_bf16 v[48:51], v[128:131], a[0:3], 0
  ds_read_b128 v[152:155], v104 offset:63488
  v_mfma_f32_16x16x32_bf16 v[52:55], v[128:131], a[80:83], 0
  v_mfma_f32_16x16x32_bf16 v[60:63], v[132:135], a[84:87], 0
  ds_read_b128 v[156:159], v104 offset:64512
  v_mfma_f32_16x16x32_bf16 v[56:59], v[132:135], a[4:7], 0
  s_waitcnt lgkmcnt(4)
  v_mfma_f32_16x16x32_bf16 v[48:51], v[136:139], a[8:11], v[48:51]
  ds_read_b128 v[128:131], v105 offset:0
  v_mfma_f32_16x16x32_bf16 v[52:55], v[136:139], a[88:91], v[52:55]
  v_mfma_f32_16x16x32_bf16 v[60:63], v[140:143], a[92:95], v[60:63]
  ds_read_b128 v[132:135], v105 offset:1024
  v_mfma_f32_16x16x32_bf16 v[56:59], v[140:143], a[12:15], v[56:59]
  s_waitcnt lgkmcnt(4)
  v_mfma_f32_16x16x32_bf16 v[48:51], v[144:147], a[16:19], v[48:51]
  ds_read_b128 v[136:139], v105 offset:2048
  v_mfma_f32_16x16x32_bf16 v[52:55], v[144:147], a[96:99], v[52:55]
  v_mfma_f32_16x16x32_bf16 v[60:63], v[148:151], a[100:103], v[60:63]
  ds_read_b128 v[140:143], v105 offset:3072
  v_mfma_f32_16x16x32_bf16 v[56:59], v[148:151], a[20:23], v[56:59]
  s_waitcnt lgkmcnt(4)
  v_mfma_f32_16x16x32_bf16 v[48:51], v[152:155], a[24:27], v[48:51]
  ds_read_b128 v[144:147], v105 offset:4096
  v_mfma_f32_16x16x32_bf16 v[52:55], v[152:155], a[104:107], v[52:55]
  v_cvt_pk_bf16_f32 v108, v32, v33
  v_mfma_f32_16x16x32_bf16 v[60:63], v[156:159], a[108:111], v[60:63]
  ds_read_b128 v[148:151], v105 offset:5120
  v_mfma_f32_16x16x32_bf16 v[56:59], v[156:159], a[28:31], v[56:59]
  v_cvt_pk_bf16_f32 v109, v34, v35
L_stub23:
  s_cbranch_execz L_scret
  s_waitcnt lgkmcnt(4)
  v_mfma_f32_16x16x32_bf16 v[48:51], v[128:131], a[32:35], v[48:51]
  ds_read_b128 v[152:155], v105 offset:6144
  v_mfma_f32_16x16x32_bf16 v[52:55], v[128:131], a[112:115], v[52:55]
  v_cvt_pk_bf16_f32 v110, v40, v41
  v_mfma_f32_16x16x32_bf16 v[60:63], v[132:135], a[116:119], v[60:63]
  ds_read_b128 v[156:159], v105 offset:7168
  v_mfma_f32_16x16x32_bf16 v[56:59], v[132:135], a[36:39], v[56:59]
  v_cvt_pk_bf16_f32 v111, v42, v43
  s_waitcnt lgkmcnt(4)
  v_mfma_f32_16x16x32_bf16 v[48:51], v[136:139], a[40:43], v[48:51]
  ds_read_b128 v[128:131], v105 offset:8192
  v_mfma_f32_16x16x32_bf16 v[52:55], v[136:139], a[120:123], v[52:55]
  buffer_store_dwordx4 v[108:111], v103, s[68:71], s21 offen offset:128
  v_mfma_f32_16x16x32_bf16 v[60:63], v[140:143], a[124:127], v[60:63]
  ds_read_b128 v[132:135], v105 offset:9216
  v_mfma_f32_16x16x32_bf16 v[56:59], v[140:143], a[44:47], v[56:59]
  v_cvt_pk_bf16_f32 v112, v36, v37
  s_waitcnt lgkmcnt(4)
  v_mfma_f32_16x16x32_bf16 v[48:51], v[144:147], a[48:51], v[48:51]
  ds_read_b128 v[136:139], v105 offset:10240
  v_mfma_f32_16x16x32_bf16 v[52:55], v[144:147], a[128:131], v[52:55]
  v_cvt_pk_bf16_f32 v113, v38, v39
  v_mfma_f32_16x16x32_bf16 v[60:63], v[148:151], a[132:135], v[60:63]
  ds_read_b128 v[140:143], v105 offset:11264
  v_mfma_f32_16x16x32_bf16 v[56:59], v[148:151], a[52:55], v[56:59]
  v_cvt_pk_bf16_f32 v114, v44, v45
  s_waitcnt lgkmcnt(4)
  v_mfma_f32_16x16x32_bf16 v[48:51], v[152:155], a[56:59], v[48:51]
  v_mfma_f32_16x16x32_bf16 v[52:55], v[152:155], a[136:139], v[52:55]
  v_cvt_pk_bf16_f32 v115, v46, v47
  v_mfma_f32_16x16x32_bf16 v[60:63], v[156:159], a[140:143], v[60:63]
  v_mfma_f32_16x16x32_bf16 v[56:59], v[156:159], a[60:63], v[56:59]
  buffer_store_dwordx4 v[112:115], v103, s[68:71], s22 offen offset:128
  s_waitcnt lgkmcnt(2)
  v_mfma_f32_16x16x32_bf16 v[48:51], v[128:131], a[64:67], v[48:51]
  v_mfma_f32_16x16x32_bf16 v[52:55], v[128:131], a[144:147], v[52:55]
  v_mfma_f32_16x16x32_bf16 v[60:63], v[132:135], a[148:151], v[60:63]
  v_mfma_f32_16x16x32_bf16 v[56:59], v[132:135], a[68:71], v[56:59]
  s_waitcnt lgkmcnt(0)
  v_mfma_f32_16x16x32_bf16 v[48:51], v[136:139], a[72:75], v[48:51]
  v_mfma_f32_16x16x32_bf16 v[52:55], v[136:139], a[152:155], v[52:55]
  v_mfma_f32_16x16x32_bf16 v[60:63], v[140:143], a[156:159], v[60:63]
  v_mfma_f32_16x16x32_bf16 v[56:59], v[140:143], a[76:79], v[56:59]
  s_nop 7
  v_pk_add_f32 v[48:49], v[48:49], v[56:57]
  v_pk_add_f32 v[50:51], v[50:51], v[58:59]
  v_cvt_pk_bf16_f32 v116, v48, v49
  v_cvt_pk_bf16_f32 v117, v50, v51
  buffer_store_dwordx2 v[116:117], v101, s[68:71], s21 offen offset:192
  v_pk_add_f32 v[52:53], v[52:53], v[60:61]
  v_pk_add_f32 v[54:55], v[54:55], v[62:63]
  v_cvt_pk_bf16_f32 v118, v52, v53
  v_cvt_pk_bf16_f32 v119, v54, v55
  buffer_store_dwordx2 v[118:119], v101, s[68:71], s22 offen offset:192
L_end:
  s_endpgm
.section .rodata,"a"
.p2align 6
.amdhsa_kernel standalone__weight_only_int_quip__prompt_kernel
  .amdhsa_next_free_vgpr 512
  .amdhsa_next_free_sgpr 102
  .amdhsa_accum_offset 256
  .amdhsa_group_segment_fixed_size 0
  .amdhsa_kernarg_size 72
  .amdhsa_user_sgpr_count 2
  .amdhsa_user_sgpr_kernarg_segment_ptr 1
  .amdhsa_system_sgpr_workgroup_id_x 1
.end_amdhsa_kernel
```
